```python
import torch

def _softmax(x, axis=-1):
    return torch.softmax(x, dim=axis)
def _gelu(x):
    return torch.nn.functional.gelu(x, approximate="tanh")
def _silu(x):
    return torch.nn.functional.silu(x)
def _sigmoid(x):
    return torch.sigmoid(x)
def _layernorm(x, axis=-1, eps=1e-5):
    m = x.mean(dim=axis, keepdim=True)
    v = x.var(dim=axis, keepdim=True, unbiased=False)
    return (x - m) / torch.sqrt(v + eps)
def _scatter_add(tgt, idx, src, axis=0):
    return tgt.clone().index_add_(axis, idx, src)
def _segment_sum(src, seg, n):
    out = torch.zeros((n,) + src.shape[1:], dtype=src.dtype)
    return out.index_add_(0, seg, src)
def _pad(x, pw):
    flat = tuple(v for pair in reversed(pw) for v in pair)
    return torch.nn.functional.pad(x, flat)

kernel_name = 'recurrent_scan__gqa_block_cached__geglu_ffn__decode'

def setup_inputs():

    _w = (lambda a: (lambda t: t.to(torch.bfloat16) if t.is_floating_point() else t)(torch.as_tensor(a)))
    def _A_setup():
        B, Sq, D = 2, 1, 576
        Hq, Hkv, Sk, Dh = 32, 16, 32768, 128
        assert Hq % Hkv == 0, (Hq, Hkv)
        return {
            "x": _w((lambda *s: torch.randn(*s, dtype=torch.bfloat16) * 0.05)(B, Sq, D)),
            "k_cache": _w((lambda *s: torch.randn(*s, dtype=torch.bfloat16) * 1.6)(B, Hkv, Sk, Dh)),
            "v_cache": _w((lambda *s: torch.randn(*s, dtype=torch.bfloat16) * 0.2)(B, Hkv, Sk, Dh)),
            "wq": _w((lambda *s: torch.randn(*s, dtype=torch.bfloat16) * 1.6)(D, Hq * Dh) * (D ** -0.5)),
            "wo": _w((lambda *s: torch.randn(*s, dtype=torch.bfloat16) * 0.2)(Hq * Dh, D) * ((Hq * Dh) ** -0.5)),
        }
    _A_in = _A_setup()

    def _B_setup():
        B, S, D, F = 2, 1, 576, 4608
        return {
            "x": _w((lambda *s: torch.randn(*s, dtype=torch.bfloat16) * 0.05)(B, S, D)),
            "w_gate": _w((lambda *s: torch.randn(*s, dtype=torch.bfloat16) * 0.1)(D, F)),
            "w_up": _w((lambda *s: torch.randn(*s, dtype=torch.bfloat16) * 0.1)(D, F)),
            "w_down": _w((lambda *s: torch.randn(*s, dtype=torch.bfloat16) * 0.1)(F, D)),
        }
    _B_in = _B_setup()

    return {
        "A_x": _A_in["x"],
        "A_k_cache": _A_in["k_cache"],
        "A_v_cache": _A_in["v_cache"],
        "A_wq": _A_in["wq"],
        "A_wo": _A_in["wo"],
        "B_x": _B_in["x"],
        "B_w_gate": _B_in["w_gate"],
        "B_w_up": _B_in["w_up"],
        "B_w_down": _B_in["w_down"],
    }

def reference(A_x, A_k_cache, A_v_cache, A_wq, A_wo, B_x, B_w_gate, B_w_up, B_w_down):
    def _A_ref(x, k_cache, v_cache, wq, wo):
        B, Sq, D = x.shape
        Hq, Dh = 32, 128
        Hkv = k_cache.shape[1]
        rep = Hq // Hkv
        q = (lambda x, *d: x.permute(*d))((x @ wq).reshape(B, Sq, Hq, Dh), 0, 2, 1, 3)
        k = (lambda x, n, axis: torch.repeat_interleave(x, n, dim=axis))(k_cache, rep, axis=1)
        v = (lambda x, n, axis: torch.repeat_interleave(x, n, dim=axis))(v_cache, rep, axis=1)
        scores = torch.einsum("bhqd,bhkd->bhqk", q, k) * (Dh ** -0.5)
        p = _softmax(scores, axis=-1)
        o = torch.einsum("bhqk,bhkd->bhqd", p, v)
        return (lambda x, *d: x.permute(*d))(o, 0, 2, 1, 3).reshape(B, Sq, Hq * Dh) @ wo

    def _B_ref(x, w_gate, w_up, w_down):
        return (_gelu(x @ w_gate) * (x @ w_up)) @ w_down

    x = A_x
    xn = _layernorm(x, axis=-1)
    s = _A_ref(xn, A_k_cache, A_v_cache, A_wq, A_wo)
    g = _silu(_B_ref(xn, B_w_gate, B_w_up, B_w_down))
    return x + s * g
```

```asm
; @launch grid=(256,1,1) block=(256,1,1) lds=149760
.amdgcn_target "amdgcn-amd-amdhsa--gfx950"
.text
.globl recurrent_scan__gqa_block_cached__geglu_ffn__decode_kernel
.p2align 8
.type recurrent_scan__gqa_block_cached__geglu_ffn__decode_kernel,@function
recurrent_scan__gqa_block_cached__geglu_ffn__decode_kernel:
  s_cmp_ge_u32 s2, 256
  s_cbranch_scc1 L_exit
  s_load_dwordx16 s[4:19], s[0:1], 0
  s_load_dwordx8 s[20:27], s[0:1], 64
  s_getpc_b64 s[64:65]
L_pc:
  s_add_u32 s64, s64, L_table-L_pc
  s_addc_u32 s65, s65, 0
  s_lshl_b32 s66, s2, 5
  s_add_u32 s64, s64, s66
  s_addc_u32 s65, s65, 0
  s_load_dwordx8 s[28:35], s[64:65], 0
  v_lshrrev_b32 v1, 6, v0
  v_and_b32 v0, 63, v0
  v_readfirstlane_b32 s3, v1
  s_lshr_b32 s36, s2, 4
  s_and_b32 s38, s2, 15
  s_lshr_b32 s37, s38, 3
  s_mov_b32 s39, s2
  s_mov_b32 s80, 0xffff0000
  s_mov_b32 s81, 0
  s_mov_b32 s82, 0
  s_mov_b32 s83, 0xffff
  s_mov_b32 s84, 0
  s_mov_b32 s85, 0xffff0000
  s_waitcnt lgkmcnt(0)
  s_load_dword s40, s[26:27], 0
  s_mov_b32 s52, s26
  s_mov_b32 s53, s27
  s_mov_b32 s54, 4194304
  s_mov_b32 s55, 0x20000
  s_cmp_ge_u32 s3, 2
  s_cbranch_scc1 L_att
  s_cmp_eq_u32 s3, 1
  s_cbranch_scc1 L_s1
  v_lshlrev_b32 v1, 4, v0
  v_mov_b32 v4, -1
  v_mov_b32 v5, -1
  v_mov_b32 v6, -1
  v_mov_b32 v7, -1
  s_lshl_b32 s64, s39, 10
  s_add_u32 s64, s64, 327680
  buffer_store_dwordx4 v[4:7], v1, s[52:55], s64 offen sc1
  s_lshl_b32 s65, s39, 7
  s_add_u32 s65, s65, 589824
  s_mov_b64 exec, 0xff
  buffer_store_dwordx4 v[4:7], v1, s[52:55], s65 offen sc1
  s_mov_b64 exec, -1
  s_and_b32 s64, s2, 7
  s_cmp_lg_u32 s64, 0
  s_cbranch_scc1 L_nocnt
  s_lshr_b32 s64, s2, 3
  s_lshl_b32 s64, s64, 8
  s_add_u32 s64, s64, 1966080
  v_mov_b32 v8, 0
  s_mov_b64 exec, 1
  buffer_store_dword v8, v1, s[52:55], s64 offen sc1
  s_mov_b64 exec, -1
L_nocnt:
  s_mov_b32 s60, s4
  s_mov_b32 s61, s5
  s_mov_b32 s62, 2304
  s_mov_b32 s63, 0x20000
  v_lshrrev_b32 v2, 5, v0
  v_mul_u32_u24 v2, 1152, v2
  v_and_b32 v3, 31, v0
  v_lshl_add_u32 v2, v3, 2, v2
  buffer_load_dword v8, v2, s[60:63], 0 offen offset:0
  buffer_load_dword v9, v2, s[60:63], 0 offen offset:128
  buffer_load_dword v10, v2, s[60:63], 0 offen offset:256
  buffer_load_dword v11, v2, s[60:63], 0 offen offset:384
  buffer_load_dword v12, v2, s[60:63], 0 offen offset:512
  buffer_load_dword v13, v2, s[60:63], 0 offen offset:640
  buffer_load_dword v14, v2, s[60:63], 0 offen offset:768
  buffer_load_dword v15, v2, s[60:63], 0 offen offset:896
  buffer_load_dword v16, v2, s[60:63], 0 offen offset:1024
  s_mov_b32 s56, s10
  s_mov_b32 s57, s11
  s_mov_b32 s58, 4718592
  s_mov_b32 s59, 0x20000
  v_lshrrev_b32 v20, 3, v0
  s_mov_b32 s64, 8192
  v_mul_lo_u32 v18, v20, s64
  v_bfe_u32 v20, v0, 4, 1
  v_lshlrev_b32 v20, 1, v20
  v_and_b32 v21, 7, v0
  v_xor_b32 v20, v20, v21
  v_lshl_add_u32 v18, v20, 4, v18
  v_xor_b32 v19, 64, v18
  s_lshr_b32 s66, s38, 2
  s_mul_i32 s67, s66, 1179648
  s_and_b32 s68, s38, 3
  s_lshl_b32 s68, s68, 7
  s_add_u32 s67, s67, s68
  s_lshl_b32 s68, s36, 9
  s_add_u32 s67, s67, s68
  s_mov_b32 s68, 6400
  s_mov_b32 s69, 9
L_wqdma:
  s_mov_b32 m0, s68
  s_add_u32 s68, s68, 1024
  buffer_load_dwordx4 v18, s[56:59], s67 offen nt lds
  s_add_u32 s67, s67, 65536
  s_mov_b32 m0, s68
  s_add_u32 s68, s68, 1024
  buffer_load_dwordx4 v19, s[56:59], s67 offen nt lds
  s_add_u32 s67, s67, 65536
  s_sub_u32 s69, s69, 1
  s_cmp_lg_u32 s69, 0
  s_cbranch_scc1 L_wqdma
  v_mov_b32 v20, 0
  ds_write_b32 v20, v20 offset:2368
  ds_write_b32 v20, v20 offset:2372
  ds_write_b32 v20, v20 offset:2376
  ds_write_b32 v20, v20 offset:2380
  ds_write_b32 v20, v20 offset:2384
  s_waitcnt lgkmcnt(0)
  s_barrier
  v_mov_b32 v20, 0
  v_mov_b32 v21, 0
  v_mov_b32 v22, 0
  v_mov_b32 v23, 0
  ds_write_b128 v1, v[20:23] offset:24832
  ds_write_b128 v1, v[20:23] offset:25856
  v_lshrrev_b32 v24, 3, v0
  v_mul_u32_u24 v24, 1184, v24
  v_and_b32 v25, 7, v0
  v_lshl_add_u32 v24, v25, 2, v24
  s_mov_b64 exec, 0xffff
  ds_write_b32 v24, v20 offset:1152
  s_mov_b64 exec, -1
  v_lshrrev_b32 v24, 4, v0
  v_bfe_u32 v25, v0, 2, 2
  v_lshl_add_u32 v100, v24, 3, v25
  v_lshlrev_b32 v100, 7, v100
  v_and_b32 v24, 1, v24
  v_lshlrev_b32 v24, 1, v24
  v_lshrrev_b32 v25, 1, v25
  v_or_b32 v24, v24, v25
  v_lshlrev_b32 v24, 1, v24
  v_bfe_u32 v25, v0, 1, 1
  v_xor_b32 v24, v24, v25
  v_lshl_add_u32 v100, v24, 4, v100
  v_and_b32 v24, 1, v0
  v_lshl_add_u32 v100, v24, 3, v100
  v_xor_b32 v101, 32, v100
  v_xor_b32 v102, 64, v100
  v_xor_b32 v103, 96, v100
  v_and_b32 v104, 1, v0
  v_mul_u32_u24 v104, 1184, v104
  v_lshrrev_b32 v24, 4, v0
  v_lshl_add_u32 v104, v24, 4, v104
  s_mul_i32 s64, s66, 288
  v_add_u32 v105, s64, v104
  s_waitcnt vmcnt(18)
  v_lshlrev_b32 v24, 16, v8
  v_and_b32 v25, 0xffff0000, v8
  v_lshlrev_b32 v26, 16, v9
  v_and_b32 v27, 0xffff0000, v9
  v_lshlrev_b32 v28, 16, v10
  v_and_b32 v29, 0xffff0000, v10
  v_lshlrev_b32 v30, 16, v11
  v_and_b32 v31, 0xffff0000, v11
  v_lshlrev_b32 v32, 16, v12
  v_and_b32 v33, 0xffff0000, v12
  v_lshlrev_b32 v34, 16, v13
  v_and_b32 v35, 0xffff0000, v13
  v_lshlrev_b32 v36, 16, v14
  v_and_b32 v37, 0xffff0000, v14
  v_lshlrev_b32 v38, 16, v15
  v_and_b32 v39, 0xffff0000, v15
  v_lshlrev_b32 v40, 16, v16
  v_and_b32 v41, 0xffff0000, v16
  v_add_f32 v42, v24, v25
  v_add_f32 v43, v26, v27
  v_add_f32 v42, v42, v28
  v_add_f32 v43, v43, v29
  v_add_f32 v42, v42, v30
  v_add_f32 v43, v43, v31
  v_add_f32 v42, v42, v32
  v_add_f32 v43, v43, v33
  v_add_f32 v42, v42, v34
  v_add_f32 v43, v43, v35
  v_add_f32 v42, v42, v36
  v_add_f32 v43, v43, v37
  v_add_f32 v42, v42, v38
  v_add_f32 v43, v43, v39
  v_add_f32 v42, v42, v40
  v_add_f32 v43, v43, v41
  v_add_f32 v42, v42, v43
  s_nop 1
  v_add_f32_dpp v42, v42, v42 row_ror:8 row_mask:0xf bank_mask:0xf
  s_nop 1
  v_add_f32_dpp v42, v42, v42 row_ror:4 row_mask:0xf bank_mask:0xf
  s_nop 1
  v_add_f32_dpp v42, v42, v42 row_ror:2 row_mask:0xf bank_mask:0xf
  s_nop 1
  v_add_f32_dpp v42, v42, v42 row_ror:1 row_mask:0xf bank_mask:0xf
  v_mov_b32 v43, v42
  s_nop 1
  v_permlane16_swap_b32 v42, v43
  v_add_f32 v42, v42, v43
  v_mul_f32 v42, 0x3ae38e39, v42
  v_mov_b32 v44, 0
  v_sub_f32 v45, v24, v42
  v_sub_f32 v46, v25, v42
  v_fmac_f32 v44, v45, v45
  v_fmac_f32 v44, v46, v46
  v_sub_f32 v45, v26, v42
  v_sub_f32 v46, v27, v42
  v_fmac_f32 v44, v45, v45
  v_fmac_f32 v44, v46, v46
  v_sub_f32 v45, v28, v42
  v_sub_f32 v46, v29, v42
  v_fmac_f32 v44, v45, v45
  v_fmac_f32 v44, v46, v46
  v_sub_f32 v45, v30, v42
  v_sub_f32 v46, v31, v42
  v_fmac_f32 v44, v45, v45
  v_fmac_f32 v44, v46, v46
  v_sub_f32 v45, v32, v42
  v_sub_f32 v46, v33, v42
  v_fmac_f32 v44, v45, v45
  v_fmac_f32 v44, v46, v46
  v_sub_f32 v45, v34, v42
  v_sub_f32 v46, v35, v42
  v_fmac_f32 v44, v45, v45
  v_fmac_f32 v44, v46, v46
  v_sub_f32 v45, v36, v42
  v_sub_f32 v46, v37, v42
  v_fmac_f32 v44, v45, v45
  v_fmac_f32 v44, v46, v46
  v_sub_f32 v45, v38, v42
  v_sub_f32 v46, v39, v42
  v_fmac_f32 v44, v45, v45
  v_fmac_f32 v44, v46, v46
  v_sub_f32 v45, v40, v42
  v_sub_f32 v46, v41, v42
  v_fmac_f32 v44, v45, v45
  v_fmac_f32 v44, v46, v46
  s_nop 1
  v_add_f32_dpp v44, v44, v44 row_ror:8 row_mask:0xf bank_mask:0xf
  s_nop 1
  v_add_f32_dpp v44, v44, v44 row_ror:4 row_mask:0xf bank_mask:0xf
  s_nop 1
  v_add_f32_dpp v44, v44, v44 row_ror:2 row_mask:0xf bank_mask:0xf
  s_nop 1
  v_add_f32_dpp v44, v44, v44 row_ror:1 row_mask:0xf bank_mask:0xf
  v_mov_b32 v43, v44
  s_nop 1
  v_permlane16_swap_b32 v44, v43
  v_add_f32 v44, v44, v43
  v_mul_f32 v44, 0x3ae38e39, v44
  v_cvt_pk_bf16_f32 v44, v44, v44
  v_and_b32 v44, 0xffff0000, v44
  v_add_f32 v44, 0x3727c5ac, v44
  v_cvt_pk_bf16_f32 v44, v44, v44
  v_and_b32 v44, 0xffff0000, v44
  v_sqrt_f32 v44, v44
  s_nop 0
  v_cvt_pk_bf16_f32 v44, v44, v44
  v_and_b32 v44, 0xffff0000, v44
  v_rcp_f32 v44, v44
  v_cvt_pk_bf16_f32 v42, v42, v42
  v_and_b32 v42, 0xffff0000, v42
  v_lshrrev_b32 v47, 5, v0
  v_mul_u32_u24 v47, 1184, v47
  v_and_b32 v48, 31, v0
  v_lshl_add_u32 v47, v48, 2, v47
  v_sub_f32 v45, v24, v42
  v_sub_f32 v46, v25, v42
  v_cvt_pk_bf16_f32 v45, v45, v46
  v_and_b32 v46, 0xffff0000, v45
  v_lshlrev_b32 v45, 16, v45
  v_mul_f32 v45, v45, v44
  v_mul_f32 v46, v46, v44
  v_cvt_pk_bf16_f32 v50, v45, v46
  ds_write_b32 v47, v50 offset:0
  v_sub_f32 v45, v26, v42
  v_sub_f32 v46, v27, v42
  v_cvt_pk_bf16_f32 v45, v45, v46
  v_and_b32 v46, 0xffff0000, v45
  v_lshlrev_b32 v45, 16, v45
  v_mul_f32 v45, v45, v44
  v_mul_f32 v46, v46, v44
  v_cvt_pk_bf16_f32 v51, v45, v46
  ds_write_b32 v47, v51 offset:128
  v_sub_f32 v45, v28, v42
  v_sub_f32 v46, v29, v42
  v_cvt_pk_bf16_f32 v45, v45, v46
  v_and_b32 v46, 0xffff0000, v45
  v_lshlrev_b32 v45, 16, v45
  v_mul_f32 v45, v45, v44
  v_mul_f32 v46, v46, v44
  v_cvt_pk_bf16_f32 v52, v45, v46
  ds_write_b32 v47, v52 offset:256
  v_sub_f32 v45, v30, v42
  v_sub_f32 v46, v31, v42
  v_cvt_pk_bf16_f32 v45, v45, v46
  v_and_b32 v46, 0xffff0000, v45
  v_lshlrev_b32 v45, 16, v45
  v_mul_f32 v45, v45, v44
  v_mul_f32 v46, v46, v44
  v_cvt_pk_bf16_f32 v53, v45, v46
  ds_write_b32 v47, v53 offset:384
  v_sub_f32 v45, v32, v42
  v_sub_f32 v46, v33, v42
  v_cvt_pk_bf16_f32 v45, v45, v46
  v_and_b32 v46, 0xffff0000, v45
  v_lshlrev_b32 v45, 16, v45
  v_mul_f32 v45, v45, v44
  v_mul_f32 v46, v46, v44
  v_cvt_pk_bf16_f32 v54, v45, v46
  ds_write_b32 v47, v54 offset:512
  v_sub_f32 v45, v34, v42
  v_sub_f32 v46, v35, v42
  v_cvt_pk_bf16_f32 v45, v45, v46
  v_and_b32 v46, 0xffff0000, v45
  v_lshlrev_b32 v45, 16, v45
  v_mul_f32 v45, v45, v44
  v_mul_f32 v46, v46, v44
  v_cvt_pk_bf16_f32 v55, v45, v46
  ds_write_b32 v47, v55 offset:640
  v_sub_f32 v45, v36, v42
  v_sub_f32 v46, v37, v42
  v_cvt_pk_bf16_f32 v45, v45, v46
  v_and_b32 v46, 0xffff0000, v45
  v_lshlrev_b32 v45, 16, v45
  v_mul_f32 v45, v45, v44
  v_mul_f32 v46, v46, v44
  v_cvt_pk_bf16_f32 v56, v45, v46
  ds_write_b32 v47, v56 offset:768
  v_sub_f32 v45, v38, v42
  v_sub_f32 v46, v39, v42
  v_cvt_pk_bf16_f32 v45, v45, v46
  v_and_b32 v46, 0xffff0000, v45
  v_lshlrev_b32 v45, 16, v45
  v_mul_f32 v45, v45, v44
  v_mul_f32 v46, v46, v44
  v_cvt_pk_bf16_f32 v57, v45, v46
  ds_write_b32 v47, v57 offset:896
  v_sub_f32 v45, v40, v42
  v_sub_f32 v46, v41, v42
  v_cvt_pk_bf16_f32 v45, v45, v46
  v_and_b32 v46, 0xffff0000, v45
  v_lshlrev_b32 v45, 16, v45
  v_mul_f32 v45, v45, v44
  v_mul_f32 v46, v46, v44
  v_cvt_pk_bf16_f32 v58, v45, v46
  ds_write_b32 v47, v58 offset:1024
  s_waitcnt vmcnt(0) lgkmcnt(0)
  s_add_u32 s42, s40, 1
  s_mul_i32 s41, s42, 0x9E3779B1
  s_xor_b32 s41, s41, 0x5bd1e995
  ds_read_b128 v[128:131], v105 offset:0
  ds_read_b64_tr_b16 v[132:133], v100 offset:6400
  ds_read_b64_tr_b16 v[134:135], v100 offset:6912
  ds_read_b64_tr_b16 v[136:137], v101 offset:6400
  ds_read_b64_tr_b16 v[138:139], v101 offset:6912
  ds_read_b64_tr_b16 v[140:141], v102 offset:6400
  ds_read_b64_tr_b16 v[142:143], v102 offset:6912
  ds_read_b64_tr_b16 v[144:145], v103 offset:6400
  ds_read_b64_tr_b16 v[146:147], v103 offset:6912
  ds_read_b128 v[148:151], v105 offset:64
  ds_read_b64_tr_b16 v[152:153], v100 offset:10496
  ds_read_b64_tr_b16 v[154:155], v100 offset:11008
  ds_read_b64_tr_b16 v[156:157], v101 offset:10496
  ds_read_b64_tr_b16 v[158:159], v101 offset:11008
  ds_read_b64_tr_b16 v[160:161], v102 offset:10496
  s_waitcnt lgkmcnt(12)
  v_mfma_f32_16x16x32_bf16 v[110:113], v[128:131], v[132:135], 0
  ds_read_b64_tr_b16 v[162:163], v102 offset:11008
  ds_read_b64_tr_b16 v[164:165], v103 offset:10496
  ds_read_b64_tr_b16 v[166:167], v103 offset:11008
  s_waitcnt lgkmcnt(13)
  v_mfma_f32_16x16x32_bf16 v[114:117], v[128:131], v[136:139], 0
  s_waitcnt lgkmcnt(11)
  v_mfma_f32_16x16x32_bf16 v[118:121], v[128:131], v[140:143], 0
  s_waitcnt lgkmcnt(9)
  v_mfma_f32_16x16x32_bf16 v[122:125], v[128:131], v[144:147], 0
  ds_read_b128 v[128:131], v105 offset:128
  ds_read_b64_tr_b16 v[132:133], v100 offset:14592
  ds_read_b64_tr_b16 v[134:135], v100 offset:15104
  ds_read_b64_tr_b16 v[136:137], v101 offset:14592
  ds_read_b64_tr_b16 v[138:139], v101 offset:15104
  ds_read_b64_tr_b16 v[140:141], v102 offset:14592
  s_waitcnt lgkmcnt(12)
  v_mfma_f32_16x16x32_bf16 v[110:113], v[148:151], v[152:155], v[110:113]
  ds_read_b64_tr_b16 v[142:143], v102 offset:15104
  ds_read_b64_tr_b16 v[144:145], v103 offset:14592
  ds_read_b64_tr_b16 v[146:147], v103 offset:15104
  s_waitcnt lgkmcnt(13)
  v_mfma_f32_16x16x32_bf16 v[114:117], v[148:151], v[156:159], v[114:117]
  s_waitcnt lgkmcnt(11)
  v_mfma_f32_16x16x32_bf16 v[118:121], v[148:151], v[160:163], v[118:121]
  s_waitcnt lgkmcnt(9)
  v_mfma_f32_16x16x32_bf16 v[122:125], v[148:151], v[164:167], v[122:125]
  ds_read_b128 v[148:151], v105 offset:192
  ds_read_b64_tr_b16 v[152:153], v100 offset:18688
  ds_read_b64_tr_b16 v[154:155], v100 offset:19200
  ds_read_b64_tr_b16 v[156:157], v101 offset:18688
  ds_read_b64_tr_b16 v[158:159], v101 offset:19200
  ds_read_b64_tr_b16 v[160:161], v102 offset:18688
  s_waitcnt lgkmcnt(12)
  v_mfma_f32_16x16x32_bf16 v[110:113], v[128:131], v[132:135], v[110:113]
  ds_read_b64_tr_b16 v[162:163], v102 offset:19200
  ds_read_b64_tr_b16 v[164:165], v103 offset:18688
  ds_read_b64_tr_b16 v[166:167], v103 offset:19200
  s_waitcnt lgkmcnt(13)
  v_mfma_f32_16x16x32_bf16 v[114:117], v[128:131], v[136:139], v[114:117]
  s_waitcnt lgkmcnt(11)
  v_mfma_f32_16x16x32_bf16 v[118:121], v[128:131], v[140:143], v[118:121]
  s_waitcnt lgkmcnt(9)
  v_mfma_f32_16x16x32_bf16 v[122:125], v[128:131], v[144:147], v[122:125]
  ds_read_b128 v[128:131], v105 offset:256
  ds_read_b64_tr_b16 v[132:133], v100 offset:22784
  ds_read_b64_tr_b16 v[134:135], v100 offset:23296
  ds_read_b64_tr_b16 v[136:137], v101 offset:22784
  ds_read_b64_tr_b16 v[138:139], v101 offset:23296
  ds_read_b64_tr_b16 v[140:141], v102 offset:22784
  s_waitcnt lgkmcnt(12)
  v_mfma_f32_16x16x32_bf16 v[110:113], v[148:151], v[152:155], v[110:113]
  ds_read_b64_tr_b16 v[142:143], v102 offset:23296
  ds_read_b64_tr_b16 v[144:145], v103 offset:22784
  ds_read_b64_tr_b16 v[146:147], v103 offset:23296
  s_waitcnt lgkmcnt(13)
  v_mfma_f32_16x16x32_bf16 v[114:117], v[148:151], v[156:159], v[114:117]
  s_waitcnt lgkmcnt(11)
  v_mfma_f32_16x16x32_bf16 v[118:121], v[148:151], v[160:163], v[118:121]
  s_waitcnt lgkmcnt(9)
  v_mfma_f32_16x16x32_bf16 v[122:125], v[148:151], v[164:167], v[122:125]
  s_waitcnt lgkmcnt(6)
  v_mfma_f32_16x16x32_bf16 v[110:113], v[128:131], v[132:135], v[110:113]
  s_waitcnt lgkmcnt(4)
  v_mfma_f32_16x16x32_bf16 v[114:117], v[128:131], v[136:139], v[114:117]
  s_waitcnt lgkmcnt(2)
  v_mfma_f32_16x16x32_bf16 v[118:121], v[128:131], v[140:143], v[118:121]
  s_waitcnt lgkmcnt(0)
  v_mfma_f32_16x16x32_bf16 v[122:125], v[128:131], v[144:147], v[122:125]
  s_nop 3
  v_cndmask_b32 v8, v110, v114, s[80:81]
  s_nop 0
  v_cndmask_b32 v8, v8, v118, s[82:83]
  s_nop 0
  v_cndmask_b32 v8, v8, v122, s[84:85]
  v_cndmask_b32 v10, v111, v115, s[80:81]
  v_cndmask_b32 v10, v10, v119, s[82:83]
  v_cndmask_b32 v10, v10, v123, s[84:85]
  v_mov_b32 v9, s41
  v_mov_b32 v11, s41
  s_lshl_b32 s64, s39, 10
  s_add_u32 s64, s64, 4096
  buffer_store_dwordx4 v[8:11], v1, s[52:55], s64 offen sc1
  v_mov_b32 v12, 0
  v_mov_b32 v13, 1
  ds_write_b32 v12, v13 offset:2376
  s_lshl_b32 s64, s37, 3
  v_add_u32 v2, s64, v1
  s_lshl_b32 s64, s36, 14
  s_add_u32 s64, s64, 4096
  s_add_u32 s65, s64, 4096
  s_add_u32 s66, s64, 8192
  s_add_u32 s67, s64, 12288
  s_mov_b32 s91, 400000
L_qpoll:
  buffer_load_dwordx2 v[24:25], v2, s[52:55], s64 offen offset:0 sc1
  buffer_load_dwordx2 v[26:27], v2, s[52:55], s64 offen offset:1024 sc1
  buffer_load_dwordx2 v[28:29], v2, s[52:55], s64 offen offset:2048 sc1
  buffer_load_dwordx2 v[30:31], v2, s[52:55], s64 offen offset:3072 sc1
  buffer_load_dwordx2 v[32:33], v2, s[52:55], s65 offen offset:0 sc1
  buffer_load_dwordx2 v[34:35], v2, s[52:55], s65 offen offset:1024 sc1
  buffer_load_dwordx2 v[36:37], v2, s[52:55], s65 offen offset:2048 sc1
  buffer_load_dwordx2 v[38:39], v2, s[52:55], s65 offen offset:3072 sc1
  buffer_load_dwordx2 v[40:41], v2, s[52:55], s66 offen offset:0 sc1
  buffer_load_dwordx2 v[42:43], v2, s[52:55], s66 offen offset:1024 sc1
  buffer_load_dwordx2 v[44:45], v2, s[52:55], s66 offen offset:2048 sc1
  buffer_load_dwordx2 v[46:47], v2, s[52:55], s66 offen offset:3072 sc1
  buffer_load_dwordx2 v[48:49], v2, s[52:55], s67 offen offset:0 sc1
  buffer_load_dwordx2 v[50:51], v2, s[52:55], s67 offen offset:1024 sc1
  buffer_load_dwordx2 v[52:53], v2, s[52:55], s67 offen offset:2048 sc1
  buffer_load_dwordx2 v[54:55], v2, s[52:55], s67 offen offset:3072 sc1
  s_waitcnt vmcnt(0)
  v_max3_u32 v60, v25, v27, v29
  v_min3_u32 v61, v25, v27, v29
  v_max3_u32 v60, v60, v31, v33
  v_min3_u32 v61, v61, v31, v33
  v_max3_u32 v60, v60, v35, v37
  v_min3_u32 v61, v61, v35, v37
  v_max3_u32 v60, v60, v39, v41
  v_min3_u32 v61, v61, v39, v41
  v_max3_u32 v60, v60, v43, v45
  v_min3_u32 v61, v61, v43, v45
  v_max3_u32 v60, v60, v47, v49
  v_min3_u32 v61, v61, v47, v49
  v_max3_u32 v60, v60, v51, v53
  v_min3_u32 v61, v61, v51, v53
  v_max3_u32 v60, v60, v55, v55
  v_min3_u32 v61, v61, v55, v55
  v_xor_b32 v60, v60, v61
  v_xor_b32 v61, s41, v61
  v_or_b32 v60, v60, v61
  v_cmp_ne_u32 vcc, 0, v60
  s_cbranch_vccz L_qpoll_ok
  s_sub_u32 s91, s91, 1
  s_cmp_eq_u32 s91, 0
  s_cbranch_scc1 L_qpoll_ok
  s_sleep 1
  s_branch L_qpoll
L_qpoll_ok:
  v_lshlrev_b32 v3, 1, v0
  v_add_f32 v60, v24, v32
  v_add_f32 v60, v60, v40
  v_add_f32 v60, v60, v48
  v_cvt_pk_bf16_f32 v62, v60, v60
  ds_write_b16 v3, v62 offset:2432
  v_add_f32 v60, v26, v34
  v_add_f32 v60, v60, v42
  v_add_f32 v60, v60, v50
  v_cvt_pk_bf16_f32 v63, v60, v60
  ds_write_b16 v3, v63 offset:2560
  v_add_f32 v60, v28, v36
  v_add_f32 v60, v60, v44
  v_add_f32 v60, v60, v52
  v_cvt_pk_bf16_f32 v64, v60, v60
  ds_write_b16 v3, v64 offset:2688
  v_add_f32 v60, v30, v38
  v_add_f32 v60, v60, v46
  v_add_f32 v60, v60, v54
  v_cvt_pk_bf16_f32 v65, v60, v60
  ds_write_b16 v3, v65 offset:2816
  s_waitcnt lgkmcnt(0)
  v_mov_b32 v12, 0
  v_mov_b32 v13, 1
  ds_write_b32 v12, v13 offset:2372
  s_cmp_eq_u32 s33, 255
  s_cbranch_scc1 L_s0_noy
  s_mov_b32 s91, 400000
  v_mov_b32 v250, 0
L_ywait:
  ds_read_b32 v251, v250 offset:2368
  s_waitcnt lgkmcnt(0)
  v_readfirstlane_b32 s90, v251
  s_cmp_ge_u32 s90, 88
  s_cbranch_scc1 L_ywait_ok
  s_sub_u32 s91, s91, 1
  s_cmp_eq_u32 s91, 0
  s_cbranch_scc1 L_ywait_ok
  s_sleep 8
  s_branch L_ywait
L_ywait_ok:
  s_lshl_b32 s64, s33, 13
  s_add_u32 s64, s64, 1048576
  s_add_u32 s65, s64, 4096
  s_mov_b32 s91, 400000
L_ypoll:
  buffer_load_dwordx4 v[24:27], v1, s[52:55], s64 offen offset:0 sc1
  buffer_load_dwordx4 v[28:31], v1, s[52:55], s64 offen offset:1024 sc1
  buffer_load_dwordx4 v[32:35], v1, s[52:55], s64 offen offset:2048 sc1
  buffer_load_dwordx4 v[36:39], v1, s[52:55], s64 offen offset:3072 sc1
  buffer_load_dwordx4 v[40:43], v1, s[52:55], s65 offen offset:0 sc1
  buffer_load_dwordx4 v[44:47], v1, s[52:55], s65 offen offset:1024 sc1
  buffer_load_dwordx4 v[48:51], v1, s[52:55], s65 offen offset:2048 sc1
  buffer_load_dwordx4 v[52:55], v1, s[52:55], s65 offen offset:3072 sc1
  s_waitcnt vmcnt(0)
  v_max3_u32 v80, v25, v27, v29
  v_min3_u32 v81, v25, v27, v29
  v_max3_u32 v80, v80, v31, v33
  v_min3_u32 v81, v81, v31, v33
  v_max3_u32 v80, v80, v35, v37
  v_min3_u32 v81, v81, v35, v37
  v_max3_u32 v80, v80, v39, v41
  v_min3_u32 v81, v81, v39, v41
  v_max3_u32 v80, v80, v43, v45
  v_min3_u32 v81, v81, v43, v45
  v_max3_u32 v80, v80, v47, v49
  v_min3_u32 v81, v81, v47, v49
  v_max3_u32 v80, v80, v51, v53
  v_min3_u32 v81, v81, v51, v53
  v_max3_u32 v80, v80, v55, v55
  v_min3_u32 v81, v81, v55, v55
  v_xor_b32 v80, v80, v81
  v_xor_b32 v81, s41, v81
  v_or_b32 v80, v80, v81
  v_cmp_ne_u32 vcc, 0, v80
  s_cbranch_vccz L_ypoll_ok
  s_sub_u32 s91, s91, 1
  s_cmp_eq_u32 s91, 0
  s_cbranch_scc1 L_ypoll_ok
  s_sleep 32
  s_branch L_ypoll
L_ypoll_ok:
  v_add_f32 v200, v24, v28
  v_add_f32 v201, v26, v30
  v_add_f32 v200, v200, v32
  v_add_f32 v201, v201, v34
  v_add_f32 v200, v200, v36
  v_add_f32 v201, v201, v38
  v_add_f32 v200, v200, v40
  v_add_f32 v201, v201, v42
  v_add_f32 v200, v200, v44
  v_add_f32 v201, v201, v46
  v_add_f32 v200, v200, v48
  v_add_f32 v201, v201, v50
  v_add_f32 v200, v200, v52
  v_add_f32 v201, v201, v54
  v_cvt_pk_bf16_f32 v200, v200, v200
  v_and_b32 v200, 0xffff0000, v200
  v_mul_f32 v80, 0xbfb8aa3b, v200
  v_exp_f32 v80, v80
  s_nop 0
  v_add_f32 v80, 1.0, v80
  v_rcp_f32 v80, v80
  s_nop 0
  v_mul_f32 v200, v200, v80
  v_cvt_pk_bf16_f32 v200, v200, v200
  v_and_b32 v200, 0xffff0000, v200
  v_cvt_pk_bf16_f32 v201, v201, v201
  v_and_b32 v201, 0xffff0000, v201
  v_mul_f32 v80, 0xbfb8aa3b, v201
  v_exp_f32 v80, v80
  s_nop 0
  v_add_f32 v80, 1.0, v80
  v_rcp_f32 v80, v80
  s_nop 0
  v_mul_f32 v201, v201, v80
  v_cvt_pk_bf16_f32 v201, v201, v201
  v_and_b32 v201, 0xffff0000, v201
  s_mov_b32 s60, s4
  s_mov_b32 s61, s5
  s_mov_b32 s62, 2304
  s_mov_b32 s63, 0x20000
  s_lshl_b32 s70, s33, 7
  v_lshlrev_b32 v204, 1, v0
  buffer_load_ushort v202, v204, s[60:63], s70 offen
  buffer_load_ushort v203, v204, s[60:63], s70 offen offset:1152
  s_waitcnt vmcnt(0)
L_s0_noy:
  s_branch L_side_tail
L_s1:
  v_lshlrev_b32 v1, 4, v0
  s_barrier
  s_waitcnt lgkmcnt(0)
  s_add_u32 s42, s40, 1
  s_mul_i32 s41, s42, 0x9E3779B1
  s_xor_b32 s41, s41, 0x5bd1e995
  s_mov_b32 s91, 3200000
  v_mov_b32 v250, 0
L_qpubwait:
  ds_read_b32 v251, v250 offset:2376
  s_waitcnt lgkmcnt(0)
  v_readfirstlane_b32 s90, v251
  s_cmp_ge_u32 s90, 1
  s_cbranch_scc1 L_qpubwait_ok
  s_sub_u32 s91, s91, 1
  s_cmp_eq_u32 s91, 0
  s_cbranch_scc1 L_qpubwait_ok
  s_sleep 1
  s_branch L_qpubwait
L_qpubwait_ok:
  s_cmp_eq_u32 s30, 0
  s_cbranch_scc1 L_s1_wo
  s_cmp_eq_u32 s30, 3
  s_cbranch_scc1 L_dn_setup
  s_cmp_eq_u32 s30, 1
  s_cselect_b32 s56, s16, s18
  s_cselect_b32 s57, s17, s19
  s_mov_b32 s58, 5308416
  s_mov_b32 s59, 0x20000
  v_lshrrev_b32 v20, 3, v0
  s_mov_b32 s64, 9216
  v_mul_lo_u32 v18, v20, s64
  v_bfe_u32 v20, v0, 4, 1
  v_lshlrev_b32 v20, 1, v20
  v_and_b32 v21, 7, v0
  v_xor_b32 v20, v20, v21
  v_lshl_add_u32 v18, v20, 4, v18
  v_xor_b32 v19, 64, v18
  s_lshl_b32 s67, s31, 7
  s_mov_b32 s71, 73728
  s_branch L_ffn_dma
L_dn_setup:
  s_mov_b32 s56, s20
  s_mov_b32 s57, s21
  s_mov_b32 s58, 5308416
  s_mov_b32 s59, 0x20000
  v_lshrrev_b32 v20, 3, v0
  s_mov_b32 s64, 1152
  v_mul_lo_u32 v18, v20, s64
  v_bfe_u32 v20, v0, 4, 1
  v_lshlrev_b32 v20, 1, v20
  v_and_b32 v21, 7, v0
  v_xor_b32 v20, v20, v21
  v_lshl_add_u32 v18, v20, 4, v18
  v_xor_b32 v19, 64, v18
  s_mul_i32 s72, s31, 57
  s_lshr_b32 s72, s72, 9
  s_mul_i32 s73, s72, 9
  s_sub_u32 s73, s31, s73
  s_mul_i32 s67, s72, 663552
  s_lshl_b32 s64, s73, 7
  s_add_u32 s67, s67, s64
  s_mov_b32 s71, 9216
L_ffn_dma:
  s_mov_b32 s68, 59648
  s_mov_b32 s69, 36
L_gudma:
  s_mov_b32 m0, s68
  s_add_u32 s68, s68, 1024
  buffer_load_dwordx4 v18, s[56:59], s67 offen nt lds
  s_add_u32 s67, s67, s71
  s_mov_b32 m0, s68
  s_add_u32 s68, s68, 1024
  buffer_load_dwordx4 v19, s[56:59], s67 offen nt lds
  s_add_u32 s67, s67, s71
  s_waitcnt vmcnt(16)
  s_sub_u32 s69, s69, 1
  s_cmp_lg_u32 s69, 0
  s_cbranch_scc1 L_gudma
L_s1_wo:
  s_branch L_s1_nowo
  s_cmp_eq_u32 s32, 255
  s_cbranch_scc1 L_s1_nowo
  s_mov_b32 s56, s12
  s_mov_b32 s57, s13
  s_mov_b32 s58, 4718592
  s_mov_b32 s59, 0x20000
  v_lshrrev_b32 v20, 3, v0
  s_mov_b32 s64, 1152
  v_mul_lo_u32 v18, v20, s64
  v_bfe_u32 v20, v0, 4, 1
  v_lshlrev_b32 v20, 1, v20
  v_and_b32 v21, 7, v0
  v_xor_b32 v20, v20, v21
  v_lshl_add_u32 v18, v20, 4, v18
  v_xor_b32 v19, 64, v18
  s_mul_i32 s67, s36, 294912
  s_lshl_b32 s68, s32, 7
  s_add_u32 s67, s67, s68
  s_mov_b32 s68, 26880
  s_mov_b32 s69, 16
L_wodma:
  s_mov_b32 m0, s68
  s_add_u32 s68, s68, 1024
  buffer_load_dwordx4 v18, s[56:59], s67 offen nt lds
  s_add_u32 s67, s67, 9216
  s_mov_b32 m0, s68
  s_add_u32 s68, s68, 1024
  buffer_load_dwordx4 v19, s[56:59], s67 offen nt lds
  s_add_u32 s67, s67, 9216
  s_waitcnt vmcnt(16)
  s_sub_u32 s69, s69, 1
  s_cmp_lg_u32 s69, 0
  s_cbranch_scc1 L_wodma
L_s1_nowo:
  s_waitcnt vmcnt(0)
  s_cmp_eq_u32 s30, 0
  s_cbranch_scc1 L_s1_ffn_done
  s_mov_b32 s91, 3200000
  v_mov_b32 v250, 0
L_xnwait:
  ds_read_b32 v251, v250 offset:2372
  s_waitcnt lgkmcnt(0)
  v_readfirstlane_b32 s90, v251
  s_cmp_ge_u32 s90, 1
  s_cbranch_scc1 L_xnwait_ok
  s_sub_u32 s91, s91, 1
  s_cmp_eq_u32 s91, 0
  s_cbranch_scc1 L_xnwait_ok
  s_sleep 4
  s_branch L_xnwait
L_xnwait_ok:
  v_lshrrev_b32 v24, 4, v0
  v_bfe_u32 v25, v0, 2, 2
  v_lshl_add_u32 v100, v24, 3, v25
  v_lshlrev_b32 v100, 7, v100
  v_and_b32 v24, 1, v24
  v_lshlrev_b32 v24, 1, v24
  v_lshrrev_b32 v25, 1, v25
  v_or_b32 v24, v24, v25
  v_lshlrev_b32 v24, 1, v24
  v_bfe_u32 v25, v0, 1, 1
  v_xor_b32 v24, v24, v25
  v_lshl_add_u32 v100, v24, 4, v100
  v_and_b32 v24, 1, v0
  v_lshl_add_u32 v100, v24, 3, v100
  v_xor_b32 v101, 32, v100
  v_xor_b32 v102, 64, v100
  v_xor_b32 v103, 96, v100
  v_and_b32 v104, 1, v0
  v_mul_u32_u24 v104, 1184, v104
  v_lshrrev_b32 v24, 4, v0
  v_lshl_add_u32 v104, v24, 4, v104
  s_cmp_eq_u32 s30, 3
  s_cbranch_scc0 L_ffn_gemv
  s_mov_b32 s91, 400000
  v_mov_b32 v250, 0
L_dnwait:
  ds_read_b32 v251, v250 offset:2368
  s_waitcnt lgkmcnt(0)
  v_readfirstlane_b32 s90, v251
  s_cmp_ge_u32 s90, 52
  s_cbranch_scc1 L_dnwait_ok
  s_sub_u32 s91, s91, 1
  s_cmp_eq_u32 s91, 0
  s_cbranch_scc1 L_dnwait_ok
  s_sleep 8
  s_branch L_dnwait
L_dnwait_ok:
  s_mul_i32 s64, s72, 18432
  s_add_u32 s64, s64, 655360
  s_add_u32 s65, s64, 4096
  s_add_u32 s66, s64, 8192
  s_add_u32 s67, s64, 12288
  s_add_u32 s68, s64, 16384
  s_mov_b32 s91, 400000
L_gupoll:
  buffer_load_dwordx4 v[24:27], v1, s[52:55], s64 offen offset:0 sc1
  buffer_load_dwordx4 v[28:31], v1, s[52:55], s64 offen offset:1024 sc1
  buffer_load_dwordx4 v[32:35], v1, s[52:55], s64 offen offset:2048 sc1
  buffer_load_dwordx4 v[36:39], v1, s[52:55], s64 offen offset:3072 sc1
  buffer_load_dwordx4 v[40:43], v1, s[52:55], s65 offen offset:0 sc1
  buffer_load_dwordx4 v[44:47], v1, s[52:55], s65 offen offset:1024 sc1
  buffer_load_dwordx4 v[48:51], v1, s[52:55], s65 offen offset:2048 sc1
  buffer_load_dwordx4 v[52:55], v1, s[52:55], s65 offen offset:3072 sc1
  buffer_load_dwordx4 v[56:59], v1, s[52:55], s66 offen offset:0 sc1
  buffer_load_dwordx4 v[60:63], v1, s[52:55], s66 offen offset:1024 sc1
  buffer_load_dwordx4 v[64:67], v1, s[52:55], s66 offen offset:2048 sc1
  buffer_load_dwordx4 v[68:71], v1, s[52:55], s66 offen offset:3072 sc1
  buffer_load_dwordx4 v[72:75], v1, s[52:55], s67 offen offset:0 sc1
  buffer_load_dwordx4 v[76:79], v1, s[52:55], s67 offen offset:1024 sc1
  buffer_load_dwordx4 v[80:83], v1, s[52:55], s67 offen offset:2048 sc1
  buffer_load_dwordx4 v[84:87], v1, s[52:55], s67 offen offset:3072 sc1
  buffer_load_dwordx4 v[88:91], v1, s[52:55], s68 offen offset:0 sc1
  buffer_load_dwordx4 v[92:95], v1, s[52:55], s68 offen offset:1024 sc1
  s_waitcnt vmcnt(0)
  v_max3_u32 v96, v25, v27, v29
  v_min3_u32 v97, v25, v27, v29
  v_max3_u32 v96, v96, v31, v33
  v_min3_u32 v97, v97, v31, v33
  v_max3_u32 v96, v96, v35, v37
  v_min3_u32 v97, v97, v35, v37
  v_max3_u32 v96, v96, v39, v41
  v_min3_u32 v97, v97, v39, v41
  v_max3_u32 v96, v96, v43, v45
  v_min3_u32 v97, v97, v43, v45
  v_max3_u32 v96, v96, v47, v49
  v_min3_u32 v97, v97, v47, v49
  v_max3_u32 v96, v96, v51, v53
  v_min3_u32 v97, v97, v51, v53
  v_max3_u32 v96, v96, v55, v57
  v_min3_u32 v97, v97, v55, v57
  v_max3_u32 v96, v96, v59, v61
  v_min3_u32 v97, v97, v59, v61
  v_max3_u32 v96, v96, v63, v65
  v_min3_u32 v97, v97, v63, v65
  v_max3_u32 v96, v96, v67, v69
  v_min3_u32 v97, v97, v67, v69
  v_max3_u32 v96, v96, v71, v73
  v_min3_u32 v97, v97, v71, v73
  v_max3_u32 v96, v96, v75, v77
  v_min3_u32 v97, v97, v75, v77
  v_max3_u32 v96, v96, v79, v81
  v_min3_u32 v97, v97, v79, v81
  v_max3_u32 v96, v96, v83, v85
  v_min3_u32 v97, v97, v83, v85
  v_max3_u32 v96, v96, v87, v89
  v_min3_u32 v97, v97, v87, v89
  v_max3_u32 v96, v96, v91, v93
  v_min3_u32 v97, v97, v91, v93
  v_max3_u32 v96, v96, v95, v95
  v_min3_u32 v97, v97, v95, v95
  v_xor_b32 v96, v96, v97
  v_xor_b32 v97, s41, v97
  v_or_b32 v96, v96, v97
  v_cmp_ne_u32 vcc, 0, v96
  s_cbranch_vccz L_gupoll_ok
  s_sub_u32 s91, s91, 1
  s_cmp_eq_u32 s91, 0
  s_cbranch_scc1 L_gupoll_ok
  s_sleep 32
  s_branch L_gupoll
L_gupoll_ok:
  v_lshlrev_b32 v3, 1, v0
  v_mov_b32 v98, 0x3d372713
  v_mul_f32 v96, v24, v24
  v_mul_f32 v96, v96, v24
  v_fma_f32 v96, v96, v98, v24
  v_mul_f32 v96, 0xc0135761, v96
  v_exp_f32 v96, v96
  s_nop 0
  v_add_f32 v96, 1.0, v96
  v_rcp_f32 v96, v96
  s_nop 0
  v_mul_f32 v96, v24, v96
  v_cvt_pk_bf16_f32 v96, v96, v96
  v_and_b32 v96, 0xffff0000, v96
  v_mul_f32 v96, v96, v28
  v_cvt_pk_bf16_f32 v97, v96, v96
  ds_write_b16 v3, v97 offset:6400
  v_mul_f32 v96, v26, v26
  v_mul_f32 v96, v96, v26
  v_fma_f32 v96, v96, v98, v26
  v_mul_f32 v96, 0xc0135761, v96
  v_exp_f32 v96, v96
  s_nop 0
  v_add_f32 v96, 1.0, v96
  v_rcp_f32 v96, v96
  s_nop 0
  v_mul_f32 v96, v26, v96
  v_cvt_pk_bf16_f32 v96, v96, v96
  v_and_b32 v96, 0xffff0000, v96
  v_mul_f32 v96, v96, v30
  v_cvt_pk_bf16_f32 v97, v96, v96
  ds_write_b16 v3, v97 offset:7584
  v_mul_f32 v96, v32, v32
  v_mul_f32 v96, v96, v32
  v_fma_f32 v96, v96, v98, v32
  v_mul_f32 v96, 0xc0135761, v96
  v_exp_f32 v96, v96
  s_nop 0
  v_add_f32 v96, 1.0, v96
  v_rcp_f32 v96, v96
  s_nop 0
  v_mul_f32 v96, v32, v96
  v_cvt_pk_bf16_f32 v96, v96, v96
  v_and_b32 v96, 0xffff0000, v96
  v_mul_f32 v96, v96, v36
  v_cvt_pk_bf16_f32 v97, v96, v96
  ds_write_b16 v3, v97 offset:6528
  v_mul_f32 v96, v34, v34
  v_mul_f32 v96, v96, v34
  v_fma_f32 v96, v96, v98, v34
  v_mul_f32 v96, 0xc0135761, v96
  v_exp_f32 v96, v96
  s_nop 0
  v_add_f32 v96, 1.0, v96
  v_rcp_f32 v96, v96
  s_nop 0
  v_mul_f32 v96, v34, v96
  v_cvt_pk_bf16_f32 v96, v96, v96
  v_and_b32 v96, 0xffff0000, v96
  v_mul_f32 v96, v96, v38
  v_cvt_pk_bf16_f32 v97, v96, v96
  ds_write_b16 v3, v97 offset:7712
  v_mul_f32 v96, v40, v40
  v_mul_f32 v96, v96, v40
  v_fma_f32 v96, v96, v98, v40
  v_mul_f32 v96, 0xc0135761, v96
  v_exp_f32 v96, v96
  s_nop 0
  v_add_f32 v96, 1.0, v96
  v_rcp_f32 v96, v96
  s_nop 0
  v_mul_f32 v96, v40, v96
  v_cvt_pk_bf16_f32 v96, v96, v96
  v_and_b32 v96, 0xffff0000, v96
  v_mul_f32 v96, v96, v44
  v_cvt_pk_bf16_f32 v97, v96, v96
  ds_write_b16 v3, v97 offset:6656
  v_mul_f32 v96, v42, v42
  v_mul_f32 v96, v96, v42
  v_fma_f32 v96, v96, v98, v42
  v_mul_f32 v96, 0xc0135761, v96
  v_exp_f32 v96, v96
  s_nop 0
  v_add_f32 v96, 1.0, v96
  v_rcp_f32 v96, v96
  s_nop 0
  v_mul_f32 v96, v42, v96
  v_cvt_pk_bf16_f32 v96, v96, v96
  v_and_b32 v96, 0xffff0000, v96
  v_mul_f32 v96, v96, v46
  v_cvt_pk_bf16_f32 v97, v96, v96
  ds_write_b16 v3, v97 offset:7840
  v_mul_f32 v96, v48, v48
  v_mul_f32 v96, v96, v48
  v_fma_f32 v96, v96, v98, v48
  v_mul_f32 v96, 0xc0135761, v96
  v_exp_f32 v96, v96
  s_nop 0
  v_add_f32 v96, 1.0, v96
  v_rcp_f32 v96, v96
  s_nop 0
  v_mul_f32 v96, v48, v96
  v_cvt_pk_bf16_f32 v96, v96, v96
  v_and_b32 v96, 0xffff0000, v96
  v_mul_f32 v96, v96, v52
  v_cvt_pk_bf16_f32 v97, v96, v96
  ds_write_b16 v3, v97 offset:6784
  v_mul_f32 v96, v50, v50
  v_mul_f32 v96, v96, v50
  v_fma_f32 v96, v96, v98, v50
  v_mul_f32 v96, 0xc0135761, v96
  v_exp_f32 v96, v96
  s_nop 0
  v_add_f32 v96, 1.0, v96
  v_rcp_f32 v96, v96
  s_nop 0
  v_mul_f32 v96, v50, v96
  v_cvt_pk_bf16_f32 v96, v96, v96
  v_and_b32 v96, 0xffff0000, v96
  v_mul_f32 v96, v96, v54
  v_cvt_pk_bf16_f32 v97, v96, v96
  ds_write_b16 v3, v97 offset:7968
  v_mul_f32 v96, v56, v56
  v_mul_f32 v96, v96, v56
  v_fma_f32 v96, v96, v98, v56
  v_mul_f32 v96, 0xc0135761, v96
  v_exp_f32 v96, v96
  s_nop 0
  v_add_f32 v96, 1.0, v96
  v_rcp_f32 v96, v96
  s_nop 0
  v_mul_f32 v96, v56, v96
  v_cvt_pk_bf16_f32 v96, v96, v96
  v_and_b32 v96, 0xffff0000, v96
  v_mul_f32 v96, v96, v60
  v_cvt_pk_bf16_f32 v97, v96, v96
  ds_write_b16 v3, v97 offset:6912
  v_mul_f32 v96, v58, v58
  v_mul_f32 v96, v96, v58
  v_fma_f32 v96, v96, v98, v58
  v_mul_f32 v96, 0xc0135761, v96
  v_exp_f32 v96, v96
  s_nop 0
  v_add_f32 v96, 1.0, v96
  v_rcp_f32 v96, v96
  s_nop 0
  v_mul_f32 v96, v58, v96
  v_cvt_pk_bf16_f32 v96, v96, v96
  v_and_b32 v96, 0xffff0000, v96
  v_mul_f32 v96, v96, v62
  v_cvt_pk_bf16_f32 v97, v96, v96
  ds_write_b16 v3, v97 offset:8096
  v_mul_f32 v96, v64, v64
  v_mul_f32 v96, v96, v64
  v_fma_f32 v96, v96, v98, v64
  v_mul_f32 v96, 0xc0135761, v96
  v_exp_f32 v96, v96
  s_nop 0
  v_add_f32 v96, 1.0, v96
  v_rcp_f32 v96, v96
  s_nop 0
  v_mul_f32 v96, v64, v96
  v_cvt_pk_bf16_f32 v96, v96, v96
  v_and_b32 v96, 0xffff0000, v96
  v_mul_f32 v96, v96, v68
  v_cvt_pk_bf16_f32 v97, v96, v96
  ds_write_b16 v3, v97 offset:7040
  v_mul_f32 v96, v66, v66
  v_mul_f32 v96, v96, v66
  v_fma_f32 v96, v96, v98, v66
  v_mul_f32 v96, 0xc0135761, v96
  v_exp_f32 v96, v96
  s_nop 0
  v_add_f32 v96, 1.0, v96
  v_rcp_f32 v96, v96
  s_nop 0
  v_mul_f32 v96, v66, v96
  v_cvt_pk_bf16_f32 v96, v96, v96
  v_and_b32 v96, 0xffff0000, v96
  v_mul_f32 v96, v96, v70
  v_cvt_pk_bf16_f32 v97, v96, v96
  ds_write_b16 v3, v97 offset:8224
  v_mul_f32 v96, v72, v72
  v_mul_f32 v96, v96, v72
  v_fma_f32 v96, v96, v98, v72
  v_mul_f32 v96, 0xc0135761, v96
  v_exp_f32 v96, v96
  s_nop 0
  v_add_f32 v96, 1.0, v96
  v_rcp_f32 v96, v96
  s_nop 0
  v_mul_f32 v96, v72, v96
  v_cvt_pk_bf16_f32 v96, v96, v96
  v_and_b32 v96, 0xffff0000, v96
  v_mul_f32 v96, v96, v76
  v_cvt_pk_bf16_f32 v97, v96, v96
  ds_write_b16 v3, v97 offset:7168
  v_mul_f32 v96, v74, v74
  v_mul_f32 v96, v96, v74
  v_fma_f32 v96, v96, v98, v74
  v_mul_f32 v96, 0xc0135761, v96
  v_exp_f32 v96, v96
  s_nop 0
  v_add_f32 v96, 1.0, v96
  v_rcp_f32 v96, v96
  s_nop 0
  v_mul_f32 v96, v74, v96
  v_cvt_pk_bf16_f32 v96, v96, v96
  v_and_b32 v96, 0xffff0000, v96
  v_mul_f32 v96, v96, v78
  v_cvt_pk_bf16_f32 v97, v96, v96
  ds_write_b16 v3, v97 offset:8352
  v_mul_f32 v96, v80, v80
  v_mul_f32 v96, v96, v80
  v_fma_f32 v96, v96, v98, v80
  v_mul_f32 v96, 0xc0135761, v96
  v_exp_f32 v96, v96
  s_nop 0
  v_add_f32 v96, 1.0, v96
  v_rcp_f32 v96, v96
  s_nop 0
  v_mul_f32 v96, v80, v96
  v_cvt_pk_bf16_f32 v96, v96, v96
  v_and_b32 v96, 0xffff0000, v96
  v_mul_f32 v96, v96, v84
  v_cvt_pk_bf16_f32 v97, v96, v96
  ds_write_b16 v3, v97 offset:7296
  v_mul_f32 v96, v82, v82
  v_mul_f32 v96, v96, v82
  v_fma_f32 v96, v96, v98, v82
  v_mul_f32 v96, 0xc0135761, v96
  v_exp_f32 v96, v96
  s_nop 0
  v_add_f32 v96, 1.0, v96
  v_rcp_f32 v96, v96
  s_nop 0
  v_mul_f32 v96, v82, v96
  v_cvt_pk_bf16_f32 v96, v96, v96
  v_and_b32 v96, 0xffff0000, v96
  v_mul_f32 v96, v96, v86
  v_cvt_pk_bf16_f32 v97, v96, v96
  ds_write_b16 v3, v97 offset:8480
  v_mul_f32 v96, v88, v88
  v_mul_f32 v96, v96, v88
  v_fma_f32 v96, v96, v98, v88
  v_mul_f32 v96, 0xc0135761, v96
  v_exp_f32 v96, v96
  s_nop 0
  v_add_f32 v96, 1.0, v96
  v_rcp_f32 v96, v96
  s_nop 0
  v_mul_f32 v96, v88, v96
  v_cvt_pk_bf16_f32 v96, v96, v96
  v_and_b32 v96, 0xffff0000, v96
  v_mul_f32 v96, v96, v92
  v_cvt_pk_bf16_f32 v97, v96, v96
  ds_write_b16 v3, v97 offset:7424
  v_mul_f32 v96, v90, v90
  v_mul_f32 v96, v96, v90
  v_fma_f32 v96, v96, v98, v90
  v_mul_f32 v96, 0xc0135761, v96
  v_exp_f32 v96, v96
  s_nop 0
  v_add_f32 v96, 1.0, v96
  v_rcp_f32 v96, v96
  s_nop 0
  v_mul_f32 v96, v90, v96
  v_cvt_pk_bf16_f32 v96, v96, v96
  v_and_b32 v96, 0xffff0000, v96
  v_mul_f32 v96, v96, v94
  v_cvt_pk_bf16_f32 v97, v96, v96
  ds_write_b16 v3, v97 offset:8608
  v_add_u32 v104, 6400, v104
  s_waitcnt lgkmcnt(0)
L_ffn_gemv:
  v_add_u32 v106, 59648, v100
  v_add_u32 v170, 96512, v100
  v_add_u32 v107, 59648, v101
  v_add_u32 v171, 96512, v101
  v_add_u32 v108, 59648, v102
  v_add_u32 v172, 96512, v102
  v_add_u32 v109, 59648, v103
  v_add_u32 v173, 96512, v103
  ds_read_b128 v[128:131], v104 offset:0
  ds_read_b64_tr_b16 v[132:133], v106 offset:0
  ds_read_b64_tr_b16 v[134:135], v106 offset:512
  ds_read_b64_tr_b16 v[136:137], v107 offset:0
  ds_read_b64_tr_b16 v[138:139], v107 offset:512
  ds_read_b64_tr_b16 v[140:141], v108 offset:0
  ds_read_b64_tr_b16 v[142:143], v108 offset:512
  ds_read_b64_tr_b16 v[144:145], v109 offset:0
  ds_read_b64_tr_b16 v[146:147], v109 offset:512
  ds_read_b128 v[148:151], v104 offset:64
  ds_read_b64_tr_b16 v[152:153], v106 offset:4096
  ds_read_b64_tr_b16 v[154:155], v106 offset:4608
  ds_read_b64_tr_b16 v[156:157], v107 offset:4096
  ds_read_b64_tr_b16 v[158:159], v107 offset:4608
  ds_read_b64_tr_b16 v[160:161], v108 offset:4096
  s_waitcnt lgkmcnt(12)
  v_mfma_f32_16x16x32_bf16 v[110:113], v[128:131], v[132:135], 0
  ds_read_b64_tr_b16 v[162:163], v108 offset:4608
  ds_read_b64_tr_b16 v[164:165], v109 offset:4096
  ds_read_b64_tr_b16 v[166:167], v109 offset:4608
  s_waitcnt lgkmcnt(13)
  v_mfma_f32_16x16x32_bf16 v[114:117], v[128:131], v[136:139], 0
  s_waitcnt lgkmcnt(11)
  v_mfma_f32_16x16x32_bf16 v[118:121], v[128:131], v[140:143], 0
  s_waitcnt lgkmcnt(9)
  v_mfma_f32_16x16x32_bf16 v[122:125], v[128:131], v[144:147], 0
  ds_read_b128 v[128:131], v104 offset:128
  ds_read_b64_tr_b16 v[132:133], v106 offset:8192
  ds_read_b64_tr_b16 v[134:135], v106 offset:8704
  ds_read_b64_tr_b16 v[136:137], v107 offset:8192
  ds_read_b64_tr_b16 v[138:139], v107 offset:8704
  ds_read_b64_tr_b16 v[140:141], v108 offset:8192
  s_waitcnt lgkmcnt(12)
  v_mfma_f32_16x16x32_bf16 v[110:113], v[148:151], v[152:155], v[110:113]
  ds_read_b64_tr_b16 v[142:143], v108 offset:8704
  ds_read_b64_tr_b16 v[144:145], v109 offset:8192
  ds_read_b64_tr_b16 v[146:147], v109 offset:8704
  s_waitcnt lgkmcnt(13)
  v_mfma_f32_16x16x32_bf16 v[114:117], v[148:151], v[156:159], v[114:117]
  s_waitcnt lgkmcnt(11)
  v_mfma_f32_16x16x32_bf16 v[118:121], v[148:151], v[160:163], v[118:121]
  s_waitcnt lgkmcnt(9)
  v_mfma_f32_16x16x32_bf16 v[122:125], v[148:151], v[164:167], v[122:125]
  ds_read_b128 v[148:151], v104 offset:192
  ds_read_b64_tr_b16 v[152:153], v106 offset:12288
  ds_read_b64_tr_b16 v[154:155], v106 offset:12800
  ds_read_b64_tr_b16 v[156:157], v107 offset:12288
  ds_read_b64_tr_b16 v[158:159], v107 offset:12800
  ds_read_b64_tr_b16 v[160:161], v108 offset:12288
  s_waitcnt lgkmcnt(12)
  v_mfma_f32_16x16x32_bf16 v[110:113], v[128:131], v[132:135], v[110:113]
  ds_read_b64_tr_b16 v[162:163], v108 offset:12800
  ds_read_b64_tr_b16 v[164:165], v109 offset:12288
  ds_read_b64_tr_b16 v[166:167], v109 offset:12800
  s_waitcnt lgkmcnt(13)
  v_mfma_f32_16x16x32_bf16 v[114:117], v[128:131], v[136:139], v[114:117]
  s_waitcnt lgkmcnt(11)
  v_mfma_f32_16x16x32_bf16 v[118:121], v[128:131], v[140:143], v[118:121]
  s_waitcnt lgkmcnt(9)
  v_mfma_f32_16x16x32_bf16 v[122:125], v[128:131], v[144:147], v[122:125]
  ds_read_b128 v[128:131], v104 offset:256
  ds_read_b64_tr_b16 v[132:133], v106 offset:16384
  ds_read_b64_tr_b16 v[134:135], v106 offset:16896
  ds_read_b64_tr_b16 v[136:137], v107 offset:16384
  ds_read_b64_tr_b16 v[138:139], v107 offset:16896
  ds_read_b64_tr_b16 v[140:141], v108 offset:16384
  s_waitcnt lgkmcnt(12)
  v_mfma_f32_16x16x32_bf16 v[110:113], v[148:151], v[152:155], v[110:113]
  ds_read_b64_tr_b16 v[142:143], v108 offset:16896
  ds_read_b64_tr_b16 v[144:145], v109 offset:16384
  ds_read_b64_tr_b16 v[146:147], v109 offset:16896
  s_waitcnt lgkmcnt(13)
  v_mfma_f32_16x16x32_bf16 v[114:117], v[148:151], v[156:159], v[114:117]
  s_waitcnt lgkmcnt(11)
  v_mfma_f32_16x16x32_bf16 v[118:121], v[148:151], v[160:163], v[118:121]
  s_waitcnt lgkmcnt(9)
  v_mfma_f32_16x16x32_bf16 v[122:125], v[148:151], v[164:167], v[122:125]
  ds_read_b128 v[148:151], v104 offset:320
  ds_read_b64_tr_b16 v[152:153], v106 offset:20480
  ds_read_b64_tr_b16 v[154:155], v106 offset:20992
  ds_read_b64_tr_b16 v[156:157], v107 offset:20480
  ds_read_b64_tr_b16 v[158:159], v107 offset:20992
  ds_read_b64_tr_b16 v[160:161], v108 offset:20480
  s_waitcnt lgkmcnt(12)
  v_mfma_f32_16x16x32_bf16 v[110:113], v[128:131], v[132:135], v[110:113]
  ds_read_b64_tr_b16 v[162:163], v108 offset:20992
  ds_read_b64_tr_b16 v[164:165], v109 offset:20480
  ds_read_b64_tr_b16 v[166:167], v109 offset:20992
  s_waitcnt lgkmcnt(13)
  v_mfma_f32_16x16x32_bf16 v[114:117], v[128:131], v[136:139], v[114:117]
  s_waitcnt lgkmcnt(11)
  v_mfma_f32_16x16x32_bf16 v[118:121], v[128:131], v[140:143], v[118:121]
  s_waitcnt lgkmcnt(9)
  v_mfma_f32_16x16x32_bf16 v[122:125], v[128:131], v[144:147], v[122:125]
  ds_read_b128 v[128:131], v104 offset:384
  ds_read_b64_tr_b16 v[132:133], v106 offset:24576
  ds_read_b64_tr_b16 v[134:135], v106 offset:25088
  ds_read_b64_tr_b16 v[136:137], v107 offset:24576
  ds_read_b64_tr_b16 v[138:139], v107 offset:25088
  ds_read_b64_tr_b16 v[140:141], v108 offset:24576
  s_waitcnt lgkmcnt(12)
  v_mfma_f32_16x16x32_bf16 v[110:113], v[148:151], v[152:155], v[110:113]
  ds_read_b64_tr_b16 v[142:143], v108 offset:25088
  ds_read_b64_tr_b16 v[144:145], v109 offset:24576
  ds_read_b64_tr_b16 v[146:147], v109 offset:25088
  s_waitcnt lgkmcnt(13)
  v_mfma_f32_16x16x32_bf16 v[114:117], v[148:151], v[156:159], v[114:117]
  s_waitcnt lgkmcnt(11)
  v_mfma_f32_16x16x32_bf16 v[118:121], v[148:151], v[160:163], v[118:121]
  s_waitcnt lgkmcnt(9)
  v_mfma_f32_16x16x32_bf16 v[122:125], v[148:151], v[164:167], v[122:125]
  ds_read_b128 v[148:151], v104 offset:448
  ds_read_b64_tr_b16 v[152:153], v106 offset:28672
  ds_read_b64_tr_b16 v[154:155], v106 offset:29184
  ds_read_b64_tr_b16 v[156:157], v107 offset:28672
  ds_read_b64_tr_b16 v[158:159], v107 offset:29184
  ds_read_b64_tr_b16 v[160:161], v108 offset:28672
  s_waitcnt lgkmcnt(12)
  v_mfma_f32_16x16x32_bf16 v[110:113], v[128:131], v[132:135], v[110:113]
  ds_read_b64_tr_b16 v[162:163], v108 offset:29184
  ds_read_b64_tr_b16 v[164:165], v109 offset:28672
  ds_read_b64_tr_b16 v[166:167], v109 offset:29184
  s_waitcnt lgkmcnt(13)
  v_mfma_f32_16x16x32_bf16 v[114:117], v[128:131], v[136:139], v[114:117]
  s_waitcnt lgkmcnt(11)
  v_mfma_f32_16x16x32_bf16 v[118:121], v[128:131], v[140:143], v[118:121]
  s_waitcnt lgkmcnt(9)
  v_mfma_f32_16x16x32_bf16 v[122:125], v[128:131], v[144:147], v[122:125]
  ds_read_b128 v[128:131], v104 offset:512
  ds_read_b64_tr_b16 v[132:133], v106 offset:32768
  ds_read_b64_tr_b16 v[134:135], v106 offset:33280
  ds_read_b64_tr_b16 v[136:137], v107 offset:32768
  ds_read_b64_tr_b16 v[138:139], v107 offset:33280
  ds_read_b64_tr_b16 v[140:141], v108 offset:32768
  s_waitcnt lgkmcnt(12)
  v_mfma_f32_16x16x32_bf16 v[110:113], v[148:151], v[152:155], v[110:113]
  ds_read_b64_tr_b16 v[142:143], v108 offset:33280
  ds_read_b64_tr_b16 v[144:145], v109 offset:32768
  ds_read_b64_tr_b16 v[146:147], v109 offset:33280
  s_waitcnt lgkmcnt(13)
  v_mfma_f32_16x16x32_bf16 v[114:117], v[148:151], v[156:159], v[114:117]
  s_waitcnt lgkmcnt(11)
  v_mfma_f32_16x16x32_bf16 v[118:121], v[148:151], v[160:163], v[118:121]
  s_waitcnt lgkmcnt(9)
  v_mfma_f32_16x16x32_bf16 v[122:125], v[148:151], v[164:167], v[122:125]
  ds_read_b128 v[148:151], v104 offset:576
  ds_read_b64_tr_b16 v[152:153], v170 offset:0
  ds_read_b64_tr_b16 v[154:155], v170 offset:512
  ds_read_b64_tr_b16 v[156:157], v171 offset:0
  ds_read_b64_tr_b16 v[158:159], v171 offset:512
  ds_read_b64_tr_b16 v[160:161], v172 offset:0
  s_waitcnt lgkmcnt(12)
  v_mfma_f32_16x16x32_bf16 v[110:113], v[128:131], v[132:135], v[110:113]
  ds_read_b64_tr_b16 v[162:163], v172 offset:512
  ds_read_b64_tr_b16 v[164:165], v173 offset:0
  ds_read_b64_tr_b16 v[166:167], v173 offset:512
  s_waitcnt lgkmcnt(13)
  v_mfma_f32_16x16x32_bf16 v[114:117], v[128:131], v[136:139], v[114:117]
  s_waitcnt lgkmcnt(11)
  v_mfma_f32_16x16x32_bf16 v[118:121], v[128:131], v[140:143], v[118:121]
  s_waitcnt lgkmcnt(9)
  v_mfma_f32_16x16x32_bf16 v[122:125], v[128:131], v[144:147], v[122:125]
  ds_read_b128 v[128:131], v104 offset:640
  ds_read_b64_tr_b16 v[132:133], v170 offset:4096
  ds_read_b64_tr_b16 v[134:135], v170 offset:4608
  ds_read_b64_tr_b16 v[136:137], v171 offset:4096
  ds_read_b64_tr_b16 v[138:139], v171 offset:4608
  ds_read_b64_tr_b16 v[140:141], v172 offset:4096
  s_waitcnt lgkmcnt(12)
  v_mfma_f32_16x16x32_bf16 v[110:113], v[148:151], v[152:155], v[110:113]
  ds_read_b64_tr_b16 v[142:143], v172 offset:4608
  ds_read_b64_tr_b16 v[144:145], v173 offset:4096
  ds_read_b64_tr_b16 v[146:147], v173 offset:4608
  s_waitcnt lgkmcnt(13)
  v_mfma_f32_16x16x32_bf16 v[114:117], v[148:151], v[156:159], v[114:117]
  s_waitcnt lgkmcnt(11)
  v_mfma_f32_16x16x32_bf16 v[118:121], v[148:151], v[160:163], v[118:121]
  s_waitcnt lgkmcnt(9)
  v_mfma_f32_16x16x32_bf16 v[122:125], v[148:151], v[164:167], v[122:125]
  ds_read_b128 v[148:151], v104 offset:704
  ds_read_b64_tr_b16 v[152:153], v170 offset:8192
  ds_read_b64_tr_b16 v[154:155], v170 offset:8704
  ds_read_b64_tr_b16 v[156:157], v171 offset:8192
  ds_read_b64_tr_b16 v[158:159], v171 offset:8704
  ds_read_b64_tr_b16 v[160:161], v172 offset:8192
  s_waitcnt lgkmcnt(12)
  v_mfma_f32_16x16x32_bf16 v[110:113], v[128:131], v[132:135], v[110:113]
  ds_read_b64_tr_b16 v[162:163], v172 offset:8704
  ds_read_b64_tr_b16 v[164:165], v173 offset:8192
  ds_read_b64_tr_b16 v[166:167], v173 offset:8704
  s_waitcnt lgkmcnt(13)
  v_mfma_f32_16x16x32_bf16 v[114:117], v[128:131], v[136:139], v[114:117]
  s_waitcnt lgkmcnt(11)
  v_mfma_f32_16x16x32_bf16 v[118:121], v[128:131], v[140:143], v[118:121]
  s_waitcnt lgkmcnt(9)
  v_mfma_f32_16x16x32_bf16 v[122:125], v[128:131], v[144:147], v[122:125]
  ds_read_b128 v[128:131], v104 offset:768
  ds_read_b64_tr_b16 v[132:133], v170 offset:12288
  ds_read_b64_tr_b16 v[134:135], v170 offset:12800
  ds_read_b64_tr_b16 v[136:137], v171 offset:12288
  ds_read_b64_tr_b16 v[138:139], v171 offset:12800
  ds_read_b64_tr_b16 v[140:141], v172 offset:12288
  s_waitcnt lgkmcnt(12)
  v_mfma_f32_16x16x32_bf16 v[110:113], v[148:151], v[152:155], v[110:113]
  ds_read_b64_tr_b16 v[142:143], v172 offset:12800
  ds_read_b64_tr_b16 v[144:145], v173 offset:12288
  ds_read_b64_tr_b16 v[146:147], v173 offset:12800
  s_waitcnt lgkmcnt(13)
  v_mfma_f32_16x16x32_bf16 v[114:117], v[148:151], v[156:159], v[114:117]
  s_waitcnt lgkmcnt(11)
  v_mfma_f32_16x16x32_bf16 v[118:121], v[148:151], v[160:163], v[118:121]
  s_waitcnt lgkmcnt(9)
  v_mfma_f32_16x16x32_bf16 v[122:125], v[148:151], v[164:167], v[122:125]
  ds_read_b128 v[148:151], v104 offset:832
  ds_read_b64_tr_b16 v[152:153], v170 offset:16384
  ds_read_b64_tr_b16 v[154:155], v170 offset:16896
  ds_read_b64_tr_b16 v[156:157], v171 offset:16384
  ds_read_b64_tr_b16 v[158:159], v171 offset:16896
  ds_read_b64_tr_b16 v[160:161], v172 offset:16384
  s_waitcnt lgkmcnt(12)
  v_mfma_f32_16x16x32_bf16 v[110:113], v[128:131], v[132:135], v[110:113]
  ds_read_b64_tr_b16 v[162:163], v172 offset:16896
  ds_read_b64_tr_b16 v[164:165], v173 offset:16384
  ds_read_b64_tr_b16 v[166:167], v173 offset:16896
  s_waitcnt lgkmcnt(13)
  v_mfma_f32_16x16x32_bf16 v[114:117], v[128:131], v[136:139], v[114:117]
  s_waitcnt lgkmcnt(11)
  v_mfma_f32_16x16x32_bf16 v[118:121], v[128:131], v[140:143], v[118:121]
  s_waitcnt lgkmcnt(9)
  v_mfma_f32_16x16x32_bf16 v[122:125], v[128:131], v[144:147], v[122:125]
  ds_read_b128 v[128:131], v104 offset:896
  ds_read_b64_tr_b16 v[132:133], v170 offset:20480
  ds_read_b64_tr_b16 v[134:135], v170 offset:20992
  ds_read_b64_tr_b16 v[136:137], v171 offset:20480
  ds_read_b64_tr_b16 v[138:139], v171 offset:20992
  ds_read_b64_tr_b16 v[140:141], v172 offset:20480
  s_waitcnt lgkmcnt(12)
  v_mfma_f32_16x16x32_bf16 v[110:113], v[148:151], v[152:155], v[110:113]
  ds_read_b64_tr_b16 v[142:143], v172 offset:20992
  ds_read_b64_tr_b16 v[144:145], v173 offset:20480
  ds_read_b64_tr_b16 v[146:147], v173 offset:20992
  s_waitcnt lgkmcnt(13)
  v_mfma_f32_16x16x32_bf16 v[114:117], v[148:151], v[156:159], v[114:117]
  s_waitcnt lgkmcnt(11)
  v_mfma_f32_16x16x32_bf16 v[118:121], v[148:151], v[160:163], v[118:121]
  s_waitcnt lgkmcnt(9)
  v_mfma_f32_16x16x32_bf16 v[122:125], v[148:151], v[164:167], v[122:125]
  ds_read_b128 v[148:151], v104 offset:960
  ds_read_b64_tr_b16 v[152:153], v170 offset:24576
  ds_read_b64_tr_b16 v[154:155], v170 offset:25088
  ds_read_b64_tr_b16 v[156:157], v171 offset:24576
  ds_read_b64_tr_b16 v[158:159], v171 offset:25088
  ds_read_b64_tr_b16 v[160:161], v172 offset:24576
  s_waitcnt lgkmcnt(12)
  v_mfma_f32_16x16x32_bf16 v[110:113], v[128:131], v[132:135], v[110:113]
  ds_read_b64_tr_b16 v[162:163], v172 offset:25088
  ds_read_b64_tr_b16 v[164:165], v173 offset:24576
  ds_read_b64_tr_b16 v[166:167], v173 offset:25088
  s_waitcnt lgkmcnt(13)
  v_mfma_f32_16x16x32_bf16 v[114:117], v[128:131], v[136:139], v[114:117]
  s_waitcnt lgkmcnt(11)
  v_mfma_f32_16x16x32_bf16 v[118:121], v[128:131], v[140:143], v[118:121]
  s_waitcnt lgkmcnt(9)
  v_mfma_f32_16x16x32_bf16 v[122:125], v[128:131], v[144:147], v[122:125]
  ds_read_b128 v[128:131], v104 offset:1024
  ds_read_b64_tr_b16 v[132:133], v170 offset:28672
  ds_read_b64_tr_b16 v[134:135], v170 offset:29184
  ds_read_b64_tr_b16 v[136:137], v171 offset:28672
  ds_read_b64_tr_b16 v[138:139], v171 offset:29184
  ds_read_b64_tr_b16 v[140:141], v172 offset:28672
  s_waitcnt lgkmcnt(12)
  v_mfma_f32_16x16x32_bf16 v[110:113], v[148:151], v[152:155], v[110:113]
  ds_read_b64_tr_b16 v[142:143], v172 offset:29184
  ds_read_b64_tr_b16 v[144:145], v173 offset:28672
  ds_read_b64_tr_b16 v[146:147], v173 offset:29184
  s_waitcnt lgkmcnt(13)
  v_mfma_f32_16x16x32_bf16 v[114:117], v[148:151], v[156:159], v[114:117]
  s_waitcnt lgkmcnt(11)
  v_mfma_f32_16x16x32_bf16 v[118:121], v[148:151], v[160:163], v[118:121]
  s_waitcnt lgkmcnt(9)
  v_mfma_f32_16x16x32_bf16 v[122:125], v[148:151], v[164:167], v[122:125]
  ds_read_b128 v[148:151], v104 offset:1088
  ds_read_b64_tr_b16 v[152:153], v170 offset:32768
  ds_read_b64_tr_b16 v[154:155], v170 offset:33280
  ds_read_b64_tr_b16 v[156:157], v171 offset:32768
  ds_read_b64_tr_b16 v[158:159], v171 offset:33280
  ds_read_b64_tr_b16 v[160:161], v172 offset:32768
  s_waitcnt lgkmcnt(12)
  v_mfma_f32_16x16x32_bf16 v[110:113], v[128:131], v[132:135], v[110:113]
  ds_read_b64_tr_b16 v[162:163], v172 offset:33280
  ds_read_b64_tr_b16 v[164:165], v173 offset:32768
  ds_read_b64_tr_b16 v[166:167], v173 offset:33280
  s_waitcnt lgkmcnt(13)
  v_mfma_f32_16x16x32_bf16 v[114:117], v[128:131], v[136:139], v[114:117]
  s_waitcnt lgkmcnt(11)
  v_mfma_f32_16x16x32_bf16 v[118:121], v[128:131], v[140:143], v[118:121]
  s_waitcnt lgkmcnt(9)
  v_mfma_f32_16x16x32_bf16 v[122:125], v[128:131], v[144:147], v[122:125]
  s_waitcnt lgkmcnt(6)
  v_mfma_f32_16x16x32_bf16 v[110:113], v[148:151], v[152:155], v[110:113]
  s_waitcnt lgkmcnt(4)
  v_mfma_f32_16x16x32_bf16 v[114:117], v[148:151], v[156:159], v[114:117]
  s_waitcnt lgkmcnt(2)
  v_mfma_f32_16x16x32_bf16 v[118:121], v[148:151], v[160:163], v[118:121]
  s_waitcnt lgkmcnt(0)
  v_mfma_f32_16x16x32_bf16 v[122:125], v[148:151], v[164:167], v[122:125]
  s_nop 3
  v_cndmask_b32 v8, v110, v114, s[80:81]
  s_nop 0
  v_cndmask_b32 v8, v8, v118, s[82:83]
  s_nop 0
  v_cndmask_b32 v8, v8, v122, s[84:85]
  v_cndmask_b32 v10, v111, v115, s[80:81]
  v_cndmask_b32 v10, v10, v119, s[82:83]
  v_cndmask_b32 v10, v10, v123, s[84:85]
  v_mov_b32 v9, s41
  v_mov_b32 v11, s41
  s_cmp_eq_u32 s30, 3
  s_cbranch_scc1 L_dn_pub
  v_cvt_pk_bf16_f32 v8, v8, v8
  v_and_b32 v8, 0xffff0000, v8
  v_cvt_pk_bf16_f32 v10, v10, v10
  v_and_b32 v10, 0xffff0000, v10
  s_lshl_b32 s64, s31, 1
  s_add_u32 s64, s64, s30
  s_sub_u32 s64, s64, 1
  s_lshl_b32 s64, s64, 10
  s_add_u32 s64, s64, 655360
  s_branch L_ffn_pub
L_dn_pub:
  s_lshl_b32 s64, s73, 3
  s_add_u32 s64, s64, s72
  s_lshl_b32 s64, s64, 10
  s_add_u32 s64, s64, 1048576
L_ffn_pub:
  buffer_store_dwordx4 v[8:11], v1, s[52:55], s64 offen sc1
L_s1_ffn_done:
L_side_tail:
  v_lshrrev_b32 v24, 4, v0
  v_bfe_u32 v25, v0, 2, 2
  v_lshl_add_u32 v100, v24, 3, v25
  v_lshlrev_b32 v100, 7, v100
  v_and_b32 v24, 1, v24
  v_lshlrev_b32 v24, 1, v24
  v_lshrrev_b32 v25, 1, v25
  v_or_b32 v24, v24, v25
  v_lshlrev_b32 v24, 1, v24
  v_bfe_u32 v25, v0, 1, 1
  v_xor_b32 v24, v24, v25
  v_lshl_add_u32 v100, v24, 4, v100
  v_and_b32 v24, 1, v0
  v_lshl_add_u32 v100, v24, 3, v100
  v_xor_b32 v101, 32, v100
  v_xor_b32 v102, 64, v100
  v_xor_b32 v103, 96, v100
  s_lshl_b32 s64, s3, 5
  v_xor_b32 v100, s64, v100
  v_and_b32 v104, 1, v0
  v_mul_u32_u24 v104, 576, v104
  v_lshrrev_b32 v24, 4, v0
  v_lshl_add_u32 v104, v24, 4, v104
  v_lshlrev_b32 v105, 4, v0
  v_mov_b32 v9, s41
  v_mov_b32 v11, s41
  s_lshl_b32 s87, s32, 14
  s_lshl_b32 s65, s36, 10
  s_add_u32 s87, s87, s65
  s_lshl_b32 s65, s3, 8
  s_add_u32 s87, s87, s65
  s_add_u32 s87, s87, 1769472
  v_lshlrev_b32 v1, 4, v0
  v_bfe_u32 v2, v0, 2, 1
  v_lshlrev_b32 v2, 3, v2
  s_lshl_b32 s64, s36, 4
  s_lshl_b32 s65, s3, 3
  s_add_u32 s64, s64, s65
  s_lshl_b32 s66, s64, 7
  s_add_u32 s66, s66, 589824
  s_lshl_b32 s64, s64, 10
  s_add_u32 s64, s64, 327680
  s_add_u32 s65, s64, 4096
  v_bfe_u32 v90, v0, 2, 1
  v_lshlrev_b32 v90, 8, v90
  v_lshrrev_b32 v83, 4, v0
  v_lshl_add_u32 v90, v83, 6, v90
  v_and_b32 v83, 3, v0
  v_lshl_add_u32 v90, v83, 1, v90
  v_bfe_u32 v83, v0, 3, 1
  v_lshl_add_u32 v90, v83, 3, v90
  s_mul_i32 s68, s3, 576
  v_add_u32 v90, s68, v90
  s_mov_b32 s67, 0xff
  s_mov_b32 s56, s12
  s_mov_b32 s57, s13
  s_mov_b32 s58, 4718592
  s_mov_b32 s59, 0x20000
  v_lshrrev_b32 v20, 3, v0
  s_mov_b32 s64, 1152
  v_mul_lo_u32 v18, v20, s64
  v_bfe_u32 v20, v0, 4, 1
  v_lshlrev_b32 v20, 1, v20
  v_and_b32 v21, 7, v0
  v_xor_b32 v20, v20, v21
  v_lshl_add_u32 v18, v20, 4, v18
  v_xor_b32 v19, 64, v18
  s_lshl_b32 s69, s36, 1
  s_add_u32 s69, s69, s3
  s_mul_i32 s69, s69, 147456
  s_lshl_b32 s71, s32, 7
  s_add_u32 s69, s69, s71
  s_lshl_b32 s71, s3, 14
  s_add_u32 s71, s71, 26880
  s_lshl_b32 s64, s36, 4
  s_lshl_b32 s72, s3, 3
  s_add_u32 s64, s64, s72
  s_lshl_b32 s64, s64, 10
  s_add_u32 s64, s64, 327680
  s_barrier
  s_cmp_eq_u32 s32, 255
  s_cbranch_scc1 L_final
  s_mov_b32 m0, s71
  s_add_u32 s71, s71, 1024
  buffer_load_dwordx4 v18, s[56:59], s69 offen nt lds
  s_add_u32 s69, s69, 9216
  s_mov_b32 m0, s71
  s_add_u32 s71, s71, 1024
  buffer_load_dwordx4 v19, s[56:59], s69 offen nt lds
  s_add_u32 s69, s69, 9216
  s_mov_b32 m0, s71
  s_add_u32 s71, s71, 1024
  buffer_load_dwordx4 v18, s[56:59], s69 offen nt lds
  s_add_u32 s69, s69, 9216
  s_mov_b32 m0, s71
  s_add_u32 s71, s71, 1024
  buffer_load_dwordx4 v19, s[56:59], s69 offen nt lds
  s_add_u32 s69, s69, 9216
  s_mov_b32 m0, s71
  s_add_u32 s71, s71, 1024
  buffer_load_dwordx4 v18, s[56:59], s69 offen nt lds
  s_add_u32 s69, s69, 9216
  s_mov_b32 m0, s71
  s_add_u32 s71, s71, 1024
  buffer_load_dwordx4 v19, s[56:59], s69 offen nt lds
  s_add_u32 s69, s69, 9216
  s_mov_b32 m0, s71
  s_add_u32 s71, s71, 1024
  buffer_load_dwordx4 v18, s[56:59], s69 offen nt lds
  s_add_u32 s69, s69, 9216
  s_mov_b32 m0, s71
  s_add_u32 s71, s71, 1024
  buffer_load_dwordx4 v19, s[56:59], s69 offen nt lds
  s_add_u32 s69, s69, 9216
  s_mov_b32 m0, s71
  s_add_u32 s71, s71, 1024
  buffer_load_dwordx4 v18, s[56:59], s69 offen nt lds
  s_add_u32 s69, s69, 9216
  s_mov_b32 m0, s71
  s_add_u32 s71, s71, 1024
  buffer_load_dwordx4 v19, s[56:59], s69 offen nt lds
  s_add_u32 s69, s69, 9216
  s_mov_b32 m0, s71
  s_add_u32 s71, s71, 1024
  buffer_load_dwordx4 v18, s[56:59], s69 offen nt lds
  s_add_u32 s69, s69, 9216
  s_mov_b32 m0, s71
  s_add_u32 s71, s71, 1024
  buffer_load_dwordx4 v19, s[56:59], s69 offen nt lds
  s_add_u32 s69, s69, 9216
  s_mov_b32 m0, s71
  s_add_u32 s71, s71, 1024
  buffer_load_dwordx4 v18, s[56:59], s69 offen nt lds
  s_add_u32 s69, s69, 9216
  s_mov_b32 m0, s71
  s_add_u32 s71, s71, 1024
  buffer_load_dwordx4 v19, s[56:59], s69 offen nt lds
  s_add_u32 s69, s69, 9216
  s_mov_b32 m0, s71
  s_add_u32 s71, s71, 1024
  buffer_load_dwordx4 v18, s[56:59], s69 offen nt lds
  s_add_u32 s69, s69, 9216
  s_mov_b32 m0, s71
  s_add_u32 s71, s71, 1024
  buffer_load_dwordx4 v19, s[56:59], s69 offen nt lds
  s_add_u32 s69, s69, 9216
  s_mov_b32 s91, 400000
L_h1poll:
  buffer_load_dwordx4 v[24:27], v1, s[52:55], s64 offen offset:0 sc1
  buffer_load_dwordx2 v[56:57], v2, s[52:55], s66 offen offset:0 sc1
  buffer_load_dwordx4 v[28:31], v1, s[52:55], s64 offen offset:1024 sc1
  buffer_load_dwordx2 v[58:59], v2, s[52:55], s66 offen offset:128 sc1
  buffer_load_dwordx4 v[32:35], v1, s[52:55], s64 offen offset:2048 sc1
  buffer_load_dwordx2 v[60:61], v2, s[52:55], s66 offen offset:256 sc1
  buffer_load_dwordx4 v[36:39], v1, s[52:55], s64 offen offset:3072 sc1
  buffer_load_dwordx2 v[62:63], v2, s[52:55], s66 offen offset:384 sc1
  buffer_load_dwordx4 v[40:43], v1, s[52:55], s65 offen offset:0 sc1
  buffer_load_dwordx2 v[64:65], v2, s[52:55], s66 offen offset:512 sc1
  buffer_load_dwordx4 v[44:47], v1, s[52:55], s65 offen offset:1024 sc1
  buffer_load_dwordx2 v[66:67], v2, s[52:55], s66 offen offset:640 sc1
  buffer_load_dwordx4 v[48:51], v1, s[52:55], s65 offen offset:2048 sc1
  buffer_load_dwordx2 v[68:69], v2, s[52:55], s66 offen offset:768 sc1
  buffer_load_dwordx4 v[52:55], v1, s[52:55], s65 offen offset:3072 sc1
  buffer_load_dwordx2 v[70:71], v2, s[52:55], s66 offen offset:896 sc1
  s_waitcnt vmcnt(0)
  v_max3_u32 v80, v24, v25, v26
  v_max3_u32 v80, v80, v27, v28
  v_max3_u32 v80, v80, v29, v30
  v_max3_u32 v80, v80, v31, v32
  v_max3_u32 v80, v80, v33, v34
  v_max3_u32 v80, v80, v35, v36
  v_max3_u32 v80, v80, v37, v38
  v_max3_u32 v80, v80, v39, v40
  v_max3_u32 v80, v80, v41, v42
  v_max3_u32 v80, v80, v43, v44
  v_max3_u32 v80, v80, v45, v46
  v_max3_u32 v80, v80, v47, v48
  v_max3_u32 v80, v80, v49, v50
  v_max3_u32 v80, v80, v51, v52
  v_max3_u32 v80, v80, v53, v54
  v_max3_u32 v80, v80, v55, v56
  v_max3_u32 v80, v80, v57, v58
  v_max3_u32 v80, v80, v59, v60
  v_max3_u32 v80, v80, v61, v62
  v_max3_u32 v80, v80, v63, v64
  v_max3_u32 v80, v80, v65, v66
  v_max3_u32 v80, v80, v67, v68
  v_max3_u32 v80, v80, v69, v70
  v_max3_u32 v80, v80, v71, v71
  v_cmp_eq_u32 vcc, -1, v80
  s_mov_b32 s67, 0
  s_cbranch_vccz L_h1poll_ok
  s_mov_b32 s67, 1
  s_waitcnt vmcnt(0)
  s_cmp_eq_u32 s67, 0
  s_cbranch_scc1 L_h1poll_ok
  s_sub_u32 s91, s91, 1
  s_cmp_eq_u32 s91, 0
  s_cbranch_scc1 L_h1poll_ok
  s_branch L_h1poll
L_h1poll_ok:
  v_max3_f32 v80, v56, v58, v60
  v_max3_f32 v80, v80, v62, v64
  v_max3_f32 v80, v80, v66, v68
  v_max_f32 v80, v80, v70
  v_sub_f32 v56, v56, v80
  v_sub_f32 v58, v58, v80
  v_sub_f32 v60, v60, v80
  v_sub_f32 v62, v62, v80
  v_sub_f32 v64, v64, v80
  v_sub_f32 v66, v66, v80
  v_sub_f32 v68, v68, v80
  v_sub_f32 v70, v70, v80
  v_exp_f32 v56, v56
  v_exp_f32 v58, v58
  v_exp_f32 v60, v60
  v_exp_f32 v62, v62
  v_exp_f32 v64, v64
  v_exp_f32 v66, v66
  v_exp_f32 v68, v68
  v_exp_f32 v70, v70
  v_mul_f32 v81, v56, v57
  v_mul_f32 v84, v56, v24
  v_mul_f32 v85, v56, v25
  v_mul_f32 v86, v56, v26
  v_mul_f32 v87, v56, v27
  v_fmac_f32 v81, v58, v59
  v_fmac_f32 v84, v58, v28
  v_fmac_f32 v85, v58, v29
  v_fmac_f32 v86, v58, v30
  v_fmac_f32 v87, v58, v31
  v_fmac_f32 v81, v60, v61
  v_fmac_f32 v84, v60, v32
  v_fmac_f32 v85, v60, v33
  v_fmac_f32 v86, v60, v34
  v_fmac_f32 v87, v60, v35
  v_fmac_f32 v81, v62, v63
  v_fmac_f32 v84, v62, v36
  v_fmac_f32 v85, v62, v37
  v_fmac_f32 v86, v62, v38
  v_fmac_f32 v87, v62, v39
  v_fmac_f32 v81, v64, v65
  v_fmac_f32 v84, v64, v40
  v_fmac_f32 v85, v64, v41
  v_fmac_f32 v86, v64, v42
  v_fmac_f32 v87, v64, v43
  v_fmac_f32 v81, v66, v67
  v_fmac_f32 v84, v66, v44
  v_fmac_f32 v85, v66, v45
  v_fmac_f32 v86, v66, v46
  v_fmac_f32 v87, v66, v47
  v_fmac_f32 v81, v68, v69
  v_fmac_f32 v84, v68, v48
  v_fmac_f32 v85, v68, v49
  v_fmac_f32 v86, v68, v50
  v_fmac_f32 v87, v68, v51
  v_fmac_f32 v81, v70, v71
  v_fmac_f32 v84, v70, v52
  v_fmac_f32 v85, v70, v53
  v_fmac_f32 v86, v70, v54
  v_fmac_f32 v87, v70, v55
  v_rcp_f32 v81, v81
  s_nop 0
  v_mul_f32 v84, v84, v81
  v_mul_f32 v85, v85, v81
  v_mul_f32 v86, v86, v81
  v_mul_f32 v87, v87, v81
  v_cvt_pk_bf16_f32 v88, v84, v85
  v_cvt_pk_bf16_f32 v89, v86, v87
  ds_write_b16 v90, v88 offset:3072
  ds_write_b16_d16_hi v90, v88 offset:3088
  ds_write_b16 v90, v89 offset:3104
  ds_write_b16_d16_hi v90, v89 offset:3120
  s_waitcnt lgkmcnt(0)
L_wogemv:
  s_barrier
  ds_read_b128 v[128:131], v104 offset:3072
  ds_read_b64_tr_b16 v[132:133], v100 offset:26880
  ds_read_b64_tr_b16 v[134:135], v100 offset:27392
  ds_read_b128 v[136:139], v104 offset:3136
  ds_read_b64_tr_b16 v[140:141], v100 offset:30976
  ds_read_b64_tr_b16 v[142:143], v100 offset:31488
  ds_read_b128 v[144:147], v104 offset:3200
  ds_read_b64_tr_b16 v[148:149], v100 offset:35072
  ds_read_b64_tr_b16 v[150:151], v100 offset:35584
  ds_read_b128 v[152:155], v104 offset:3264
  ds_read_b64_tr_b16 v[156:157], v100 offset:39168
  ds_read_b64_tr_b16 v[158:159], v100 offset:39680
  ds_read_b128 v[160:163], v104 offset:3328
  ds_read_b64_tr_b16 v[164:165], v100 offset:43264
  ds_read_b64_tr_b16 v[166:167], v100 offset:43776
  s_waitcnt lgkmcnt(12)
  v_mfma_f32_16x16x32_bf16 v[110:113], v[128:131], v[132:135], 0
  ds_read_b128 v[168:171], v104 offset:3392
  ds_read_b64_tr_b16 v[172:173], v100 offset:47360
  ds_read_b64_tr_b16 v[174:175], v100 offset:47872
  s_waitcnt lgkmcnt(12)
  v_mfma_f32_16x16x32_bf16 v[110:113], v[136:139], v[140:143], v[110:113]
  ds_read_b128 v[176:179], v104 offset:3456
  ds_read_b64_tr_b16 v[180:181], v100 offset:51456
  ds_read_b64_tr_b16 v[182:183], v100 offset:51968
  s_waitcnt lgkmcnt(12)
  v_mfma_f32_16x16x32_bf16 v[110:113], v[144:147], v[148:151], v[110:113]
  ds_read_b128 v[184:187], v104 offset:3520
  ds_read_b64_tr_b16 v[188:189], v100 offset:55552
  ds_read_b64_tr_b16 v[190:191], v100 offset:56064
  s_waitcnt lgkmcnt(12)
  v_mfma_f32_16x16x32_bf16 v[110:113], v[152:155], v[156:159], v[110:113]
  s_waitcnt lgkmcnt(9)
  v_mfma_f32_16x16x32_bf16 v[110:113], v[160:163], v[164:167], v[110:113]
  s_waitcnt lgkmcnt(6)
  v_mfma_f32_16x16x32_bf16 v[110:113], v[168:171], v[172:175], v[110:113]
  s_waitcnt lgkmcnt(3)
  v_mfma_f32_16x16x32_bf16 v[110:113], v[176:179], v[180:183], v[110:113]
  s_waitcnt lgkmcnt(0)
  v_mfma_f32_16x16x32_bf16 v[110:113], v[184:187], v[188:191], v[110:113]
  s_nop 7
  v_mov_b32 v8, v110
  v_mov_b32 v10, v111
  s_mov_b64 exec, 0xffff
  buffer_store_dwordx4 v[8:11], v105, s[52:55], s87 offen sc1
  s_mov_b64 exec, -1
L_final:
  s_cmp_lg_u32 s3, 0
  s_cbranch_scc1 L_end
  s_cmp_eq_u32 s33, 255
  s_cbranch_scc1 L_end
  v_lshlrev_b32 v1, 4, v0
  s_lshl_b32 s64, s33, 14
  s_add_u32 s64, s64, 1769472
  s_add_u32 s65, s64, 4096
  s_add_u32 s66, s64, 8192
  s_add_u32 s67, s64, 12288
  s_mov_b32 s60, s22
  s_mov_b32 s61, s23
  s_mov_b32 s62, 2304
  s_mov_b32 s63, 0x20000
  v_lshlrev_b32 v204, 1, v0
  s_lshl_b32 s70, s33, 7
  v_lshlrev_b32 v202, 16, v202
  v_lshlrev_b32 v203, 16, v203
  s_mov_b32 s91, 400000
L_h2poll:
  buffer_load_dwordx4 v[24:27], v1, s[52:55], s64 offen offset:0 sc1
  buffer_load_dwordx4 v[28:31], v1, s[52:55], s64 offen offset:1024 sc1
  buffer_load_dwordx4 v[32:35], v1, s[52:55], s64 offen offset:2048 sc1
  buffer_load_dwordx4 v[36:39], v1, s[52:55], s64 offen offset:3072 sc1
  buffer_load_dwordx4 v[40:43], v1, s[52:55], s65 offen offset:0 sc1
  buffer_load_dwordx4 v[44:47], v1, s[52:55], s65 offen offset:1024 sc1
  buffer_load_dwordx4 v[48:51], v1, s[52:55], s65 offen offset:2048 sc1
  buffer_load_dwordx4 v[52:55], v1, s[52:55], s65 offen offset:3072 sc1
  buffer_load_dwordx4 v[56:59], v1, s[52:55], s66 offen offset:0 sc1
  buffer_load_dwordx4 v[60:63], v1, s[52:55], s66 offen offset:1024 sc1
  buffer_load_dwordx4 v[64:67], v1, s[52:55], s66 offen offset:2048 sc1
  buffer_load_dwordx4 v[68:71], v1, s[52:55], s66 offen offset:3072 sc1
  buffer_load_dwordx4 v[72:75], v1, s[52:55], s67 offen offset:0 sc1
  buffer_load_dwordx4 v[76:79], v1, s[52:55], s67 offen offset:1024 sc1
  buffer_load_dwordx4 v[80:83], v1, s[52:55], s67 offen offset:2048 sc1
  buffer_load_dwordx4 v[84:87], v1, s[52:55], s67 offen offset:3072 sc1
  s_waitcnt vmcnt(0)
  v_max3_u32 v96, v25, v27, v29
  v_min3_u32 v97, v25, v27, v29
  v_max3_u32 v96, v96, v31, v33
  v_min3_u32 v97, v97, v31, v33
  v_max3_u32 v96, v96, v35, v37
  v_min3_u32 v97, v97, v35, v37
  v_max3_u32 v96, v96, v39, v41
  v_min3_u32 v97, v97, v39, v41
  v_max3_u32 v96, v96, v43, v45
  v_min3_u32 v97, v97, v43, v45
  v_max3_u32 v96, v96, v47, v49
  v_min3_u32 v97, v97, v47, v49
  v_max3_u32 v96, v96, v51, v53
  v_min3_u32 v97, v97, v51, v53
  v_max3_u32 v96, v96, v55, v57
  v_min3_u32 v97, v97, v55, v57
  v_max3_u32 v96, v96, v59, v61
  v_min3_u32 v97, v97, v59, v61
  v_max3_u32 v96, v96, v63, v65
  v_min3_u32 v97, v97, v63, v65
  v_max3_u32 v96, v96, v67, v69
  v_min3_u32 v97, v97, v67, v69
  v_max3_u32 v96, v96, v71, v73
  v_min3_u32 v97, v97, v71, v73
  v_max3_u32 v96, v96, v75, v77
  v_min3_u32 v97, v97, v75, v77
  v_max3_u32 v96, v96, v79, v81
  v_min3_u32 v97, v97, v79, v81
  v_max3_u32 v96, v96, v83, v85
  v_min3_u32 v97, v97, v83, v85
  v_max3_u32 v96, v96, v87, v87
  v_min3_u32 v97, v97, v87, v87
  v_xor_b32 v96, v96, v97
  v_xor_b32 v97, s41, v97
  v_or_b32 v96, v96, v97
  v_cmp_ne_u32 vcc, 0, v96
  s_cbranch_vccz L_h2poll_ok
  s_sub_u32 s91, s91, 1
  s_cmp_eq_u32 s91, 0
  s_cbranch_scc1 L_h2poll_ok
  s_branch L_h2poll
L_h2poll_ok:
  v_add_f32 v24, v24, v56
  v_add_f32 v26, v26, v58
  v_add_f32 v28, v28, v60
  v_add_f32 v30, v30, v62
  v_add_f32 v32, v32, v64
  v_add_f32 v34, v34, v66
  v_add_f32 v36, v36, v68
  v_add_f32 v38, v38, v70
  v_add_f32 v40, v40, v72
  v_add_f32 v42, v42, v74
  v_add_f32 v44, v44, v76
  v_add_f32 v46, v46, v78
  v_add_f32 v48, v48, v80
  v_add_f32 v50, v50, v82
  v_add_f32 v52, v52, v84
  v_add_f32 v54, v54, v86
  v_add_f32 v24, v24, v40
  v_add_f32 v26, v26, v42
  v_add_f32 v28, v28, v44
  v_add_f32 v30, v30, v46
  v_add_f32 v32, v32, v48
  v_add_f32 v34, v34, v50
  v_add_f32 v36, v36, v52
  v_add_f32 v38, v38, v54
  v_add_f32 v24, v24, v32
  v_add_f32 v26, v26, v34
  v_add_f32 v28, v28, v36
  v_add_f32 v30, v30, v38
  v_add_f32 v24, v24, v28
  v_add_f32 v26, v26, v30
  v_cvt_pk_bf16_f32 v96, v24, v26
  v_and_b32 v97, 0xffff0000, v96
  v_lshlrev_b32 v96, 16, v96
  v_mul_f32 v96, v96, v200
  v_mul_f32 v97, v97, v201
  v_cvt_pk_bf16_f32 v96, v96, v97
  v_and_b32 v97, 0xffff0000, v96
  v_lshlrev_b32 v96, 16, v96
  v_add_f32 v96, v96, v202
  v_add_f32 v97, v97, v203
  v_cvt_pk_bf16_f32 v96, v96, v97
  buffer_store_short v96, v204, s[60:63], s70 offen
  buffer_store_short_d16_hi v96, v204, s[60:63], s70 offen offset:1152
  s_cmp_lg_u32 s33, 0
  s_cbranch_scc1 L_end
  v_mov_b32 v80, s42
  v_mov_b32 v81, 0
  s_mov_b64 exec, 1
  buffer_store_dword v80, v81, s[52:55], 0 offen offset:0
  s_mov_b64 exec, -1
  s_branch L_end
L_att:
  s_sub_u32 s66, s3, 2
  s_lshl_b32 s64, s37, 4
  s_add_u32 s64, s64, s36
  s_lshr_b32 s65, s64, 9
  s_lshl_b32 s64, s64, 23
  s_add_u32 s44, s6, s64
  s_addc_u32 s45, s7, s65
  s_mov_b32 s46, 0x800000
  s_mov_b32 s47, 0x20000
  s_add_u32 s48, s8, s64
  s_addc_u32 s49, s9, s65
  s_mov_b32 s50, 0x800000
  s_mov_b32 s51, 0x20000
  s_add_u32 s70, s28, s66
  s_lshl_b32 s70, s70, 13
  s_mov_b32 s71, s70
  s_add_u32 s87, s29, 1
  s_sub_u32 s87, s87, s66
  s_lshr_b32 s87, s87, 1
  s_mov_b32 s88, s87
  s_mov_b32 s86, s87
  s_sub_u32 s75, s87, 4
  s_mov_b32 s89, 0
  s_mov_b32 s77, 0
  s_mov_b32 s80, 0
  s_lshr_b32 s64, s2, 3
  s_lshl_b32 s64, s64, 8
  s_add_u32 s64, s64, 1966080
  s_add_u32 s78, s26, s64
  s_addc_u32 s79, s27, 0
  v_bfe_u32 v6, v0, 2, 2
  v_lshlrev_b32 v6, 8, v6
  v_lshrrev_b32 v7, 4, v0
  v_lshl_add_u32 v6, v7, 6, v6
  v_and_b32 v7, 3, v0
  v_lshl_add_u32 v2, v7, 4, v6
  v_add_u32 v3, 4096, v2
  v_lshlrev_b32 v4, 4, v0
  v_add_u32 v5, 4096, v4
  buffer_load_dwordx4 a[0:3], v2, s[44:47], s70 offen offset:0 nt
  buffer_load_dwordx4 a[4:7], v2, s[44:47], s70 offen offset:1024 nt
  buffer_load_dwordx4 a[8:11], v2, s[44:47], s70 offen offset:2048 nt
  buffer_load_dwordx4 a[12:15], v2, s[44:47], s70 offen offset:3072 nt
  buffer_load_dwordx4 a[16:19], v3, s[44:47], s70 offen offset:0 nt
  buffer_load_dwordx4 a[20:23], v3, s[44:47], s70 offen offset:1024 nt
  buffer_load_dwordx4 a[24:27], v3, s[44:47], s70 offen offset:2048 nt
  buffer_load_dwordx4 a[28:31], v3, s[44:47], s70 offen offset:3072 nt
  s_add_u32 s70, s70, 16384
  s_barrier
  buffer_load_dwordx4 a[32:35], v2, s[44:47], s70 offen offset:0 nt
  buffer_load_dwordx4 a[36:39], v2, s[44:47], s70 offen offset:1024 nt
  buffer_load_dwordx4 a[40:43], v2, s[44:47], s70 offen offset:2048 nt
  buffer_load_dwordx4 a[44:47], v2, s[44:47], s70 offen offset:3072 nt
  buffer_load_dwordx4 a[48:51], v3, s[44:47], s70 offen offset:0 nt
  buffer_load_dwordx4 a[52:55], v3, s[44:47], s70 offen offset:1024 nt
  buffer_load_dwordx4 a[56:59], v3, s[44:47], s70 offen offset:2048 nt
  buffer_load_dwordx4 a[60:63], v3, s[44:47], s70 offen offset:3072 nt
  s_add_u32 s70, s70, 16384
  s_waitcnt vmcnt(8)
  buffer_load_dwordx4 a[64:67], v2, s[44:47], s70 offen offset:0 nt
  buffer_load_dwordx4 a[68:71], v2, s[44:47], s70 offen offset:1024 nt
  buffer_load_dwordx4 a[72:75], v2, s[44:47], s70 offen offset:2048 nt
  buffer_load_dwordx4 a[76:79], v2, s[44:47], s70 offen offset:3072 nt
  buffer_load_dwordx4 a[80:83], v3, s[44:47], s70 offen offset:0 nt
  buffer_load_dwordx4 a[84:87], v3, s[44:47], s70 offen offset:1024 nt
  buffer_load_dwordx4 a[88:91], v3, s[44:47], s70 offen offset:2048 nt
  buffer_load_dwordx4 a[92:95], v3, s[44:47], s70 offen offset:3072 nt
  s_add_u32 s70, s70, 16384
  s_waitcnt vmcnt(8)
  buffer_load_dwordx4 a[96:99], v2, s[44:47], s70 offen offset:0 nt
  buffer_load_dwordx4 a[100:103], v2, s[44:47], s70 offen offset:1024 nt
  buffer_load_dwordx4 a[104:107], v2, s[44:47], s70 offen offset:2048 nt
  buffer_load_dwordx4 a[108:111], v2, s[44:47], s70 offen offset:3072 nt
  buffer_load_dwordx4 a[112:115], v3, s[44:47], s70 offen offset:0 nt
  buffer_load_dwordx4 a[116:119], v3, s[44:47], s70 offen offset:1024 nt
  buffer_load_dwordx4 a[120:123], v3, s[44:47], s70 offen offset:2048 nt
  buffer_load_dwordx4 a[124:127], v3, s[44:47], s70 offen offset:3072 nt
  s_add_u32 s70, s70, 16384
  v_and_b32 v6, 3, v0
  v_bfe_u32 v7, v0, 3, 1
  v_lshl_add_u32 v6, v7, 2, v6
  v_and_b32 v7, 1, v6
  v_mov_b32 v64, 0xffff
  v_lshlrev_b32 v7, 4, v7
  v_lshlrev_b32 v64, v7, v64
  v_lshrrev_b32 v6, 1, v6
  v_cmp_eq_u32 vcc, 0, v6
  s_nop 1
  v_cndmask_b32 v24, 0, v64, vcc
  v_cmp_eq_u32 vcc, 1, v6
  s_nop 1
  v_cndmask_b32 v25, 0, v64, vcc
  v_cmp_eq_u32 vcc, 2, v6
  s_nop 1
  v_cndmask_b32 v26, 0, v64, vcc
  v_cmp_eq_u32 vcc, 3, v6
  s_nop 1
  v_cndmask_b32 v27, 0, v64, vcc
  v_mov_b32 v28, 0
  v_mov_b32 v29, 0
  v_mov_b32 v30, 0
  v_mov_b32 v31, 0
  v_mov_b32 v14, 0xff800000
  v_mov_b32 v33, 0
  v_bfe_u32 v6, v0, 2, 1
  v_lshrrev_b32 v7, 4, v0
  v_lshl_add_u32 v7, v6, 2, v7
  v_lshlrev_b32 v7, 4, v7
  s_lshl_b32 s64, s66, 13
  s_add_u32 s64, s64, 133376
  v_add_u32 v12, s64, v7
  v_mov_b32 v13, v12
  v_lshlrev_b32 v6, 8, v6
  v_lshrrev_b32 v7, 4, v0
  v_lshl_add_u32 v6, v7, 6, v6
  v_and_b32 v7, 3, v0
  v_lshl_add_u32 v6, v7, 4, v6
  s_mov_b32 s72, 0x3db504f3
  s_mov_b32 s73, 0x3fb8aa3b
  v_mov_b32 v34, 0
  s_waitcnt lgkmcnt(0)
  s_add_u32 s42, s40, 1
  s_mul_i32 s41, s42, 0x9E3779B1
  s_xor_b32 s41, s41, 0x5bd1e995
  s_mov_b32 s91, 3200000
  v_mov_b32 v66, 0
L_qwait:
  ds_read_b32 v67, v66 offset:2372
  s_waitcnt lgkmcnt(0)
  v_readfirstlane_b32 s90, v67
  s_cmp_ge_u32 s90, 1
  s_cbranch_scc1 L_qwait_ok
  s_sub_u32 s91, s91, 1
  s_cmp_eq_u32 s91, 0
  s_cbranch_scc1 L_qwait_ok
  s_sleep 1
  s_branch L_qwait
L_qwait_ok:
  ds_read_b128 v[8:11], v6 offset:2432
  s_waitcnt lgkmcnt(0)
  s_mov_b32 s76, 1
  s_atomic_add s76, s[78:79], 0 glc
  s_waitcnt vmcnt(24)
  v_mfma_f32_16x16x32_bf16 v[68:71], a[0:3], v[8:11], 0
  v_mfma_f32_16x16x32_bf16 v[72:75], a[4:7], v[8:11], 0
  v_mfma_f32_16x16x32_bf16 v[76:79], a[8:11], v[8:11], 0
  v_mfma_f32_16x16x32_bf16 v[80:83], a[12:15], v[8:11], 0
  v_mfma_f32_16x16x32_bf16 v[84:87], a[16:19], v[8:11], 0
  v_mfma_f32_16x16x32_bf16 v[88:91], a[20:23], v[8:11], 0
  v_mfma_f32_16x16x32_bf16 v[92:95], a[24:27], v[8:11], 0
  v_mfma_f32_16x16x32_bf16 v[96:99], a[28:31], v[8:11], 0
  buffer_load_dwordx4 a[0:3], v2, s[44:47], s70 offen offset:0 nt
  buffer_load_dwordx4 a[4:7], v2, s[44:47], s70 offen offset:1024 nt
  buffer_load_dwordx4 a[8:11], v2, s[44:47], s70 offen offset:2048 nt
  buffer_load_dwordx4 a[12:15], v2, s[44:47], s70 offen offset:3072 nt
  buffer_load_dwordx4 a[16:19], v3, s[44:47], s70 offen offset:0 nt
  buffer_load_dwordx4 a[20:23], v3, s[44:47], s70 offen offset:1024 nt
  buffer_load_dwordx4 a[24:27], v3, s[44:47], s70 offen offset:2048 nt
  buffer_load_dwordx4 a[28:31], v3, s[44:47], s70 offen offset:3072 nt
  s_add_u32 s70, s70, 16384
  s_sub_u32 s75, s75, 1
  v_mov_b32_dpp v36, v68 quad_perm:[0,0,0,0] row_mask:0xf bank_mask:0xf
  v_mov_b32_dpp v37, v72 quad_perm:[0,0,0,0] row_mask:0xf bank_mask:0xf
  v_mov_b32_dpp v38, v76 quad_perm:[0,0,0,0] row_mask:0xf bank_mask:0xf
  v_mov_b32_dpp v39, v80 quad_perm:[0,0,0,0] row_mask:0xf bank_mask:0xf
  v_mov_b32_dpp v40, v84 quad_perm:[0,0,0,0] row_mask:0xf bank_mask:0xf
  v_mov_b32_dpp v41, v88 quad_perm:[0,0,0,0] row_mask:0xf bank_mask:0xf
  v_mov_b32_dpp v42, v92 quad_perm:[0,0,0,0] row_mask:0xf bank_mask:0xf
  v_mov_b32_dpp v43, v96 quad_perm:[0,0,0,0] row_mask:0xf bank_mask:0xf
  v_add_f32_dpp v36, v69, v36 quad_perm:[1,1,1,1] row_mask:0xf bank_mask:0xf
  v_add_f32_dpp v37, v73, v37 quad_perm:[1,1,1,1] row_mask:0xf bank_mask:0xf
  v_add_f32_dpp v38, v77, v38 quad_perm:[1,1,1,1] row_mask:0xf bank_mask:0xf
  v_add_f32_dpp v39, v81, v39 quad_perm:[1,1,1,1] row_mask:0xf bank_mask:0xf
  v_add_f32_dpp v40, v85, v40 quad_perm:[1,1,1,1] row_mask:0xf bank_mask:0xf
  v_add_f32_dpp v41, v89, v41 quad_perm:[1,1,1,1] row_mask:0xf bank_mask:0xf
  v_add_f32_dpp v42, v93, v42 quad_perm:[1,1,1,1] row_mask:0xf bank_mask:0xf
  v_add_f32_dpp v43, v97, v43 quad_perm:[1,1,1,1] row_mask:0xf bank_mask:0xf
  v_add_f32_dpp v36, v70, v36 quad_perm:[2,2,2,2] row_mask:0xf bank_mask:0xf
  v_add_f32_dpp v37, v74, v37 quad_perm:[2,2,2,2] row_mask:0xf bank_mask:0xf
  v_add_f32_dpp v38, v78, v38 quad_perm:[2,2,2,2] row_mask:0xf bank_mask:0xf
  v_add_f32_dpp v39, v82, v39 quad_perm:[2,2,2,2] row_mask:0xf bank_mask:0xf
  v_add_f32_dpp v40, v86, v40 quad_perm:[2,2,2,2] row_mask:0xf bank_mask:0xf
  v_add_f32_dpp v41, v90, v41 quad_perm:[2,2,2,2] row_mask:0xf bank_mask:0xf
  v_add_f32_dpp v42, v94, v42 quad_perm:[2,2,2,2] row_mask:0xf bank_mask:0xf
  v_add_f32_dpp v43, v98, v43 quad_perm:[2,2,2,2] row_mask:0xf bank_mask:0xf
  v_add_f32_dpp v36, v71, v36 quad_perm:[3,3,3,3] row_mask:0xf bank_mask:0xf
  v_add_f32_dpp v37, v75, v37 quad_perm:[3,3,3,3] row_mask:0xf bank_mask:0xf
  v_add_f32_dpp v38, v79, v38 quad_perm:[3,3,3,3] row_mask:0xf bank_mask:0xf
  v_add_f32_dpp v39, v83, v39 quad_perm:[3,3,3,3] row_mask:0xf bank_mask:0xf
  v_add_f32_dpp v40, v87, v40 quad_perm:[3,3,3,3] row_mask:0xf bank_mask:0xf
  v_add_f32_dpp v41, v91, v41 quad_perm:[3,3,3,3] row_mask:0xf bank_mask:0xf
  v_add_f32_dpp v42, v95, v42 quad_perm:[3,3,3,3] row_mask:0xf bank_mask:0xf
  v_add_f32_dpp v43, v99, v43 quad_perm:[3,3,3,3] row_mask:0xf bank_mask:0xf
  v_cvt_pk_bf16_f32 v64, v36, v37
  v_cvt_pk_bf16_f32 v65, v38, v39
  v_cvt_pk_bf16_f32 v66, v40, v41
  v_cvt_pk_bf16_f32 v67, v42, v43
  v_lshlrev_b32 v36, 16, v64
  v_and_b32 v37, 0xffff0000, v64
  v_lshlrev_b32 v38, 16, v65
  v_and_b32 v39, 0xffff0000, v65
  v_lshlrev_b32 v40, 16, v66
  v_and_b32 v41, 0xffff0000, v66
  v_lshlrev_b32 v42, 16, v67
  v_and_b32 v43, 0xffff0000, v67
  v_mul_f32 v36, s72, v36
  v_mul_f32 v37, s72, v37
  v_mul_f32 v38, s72, v38
  v_mul_f32 v39, s72, v39
  v_mul_f32 v40, s72, v40
  v_mul_f32 v41, s72, v41
  v_mul_f32 v42, s72, v42
  v_mul_f32 v43, s72, v43
  v_cvt_pk_bf16_f32 v100, v36, v37
  v_cvt_pk_bf16_f32 v101, v38, v39
  v_cvt_pk_bf16_f32 v102, v40, v41
  v_cvt_pk_bf16_f32 v103, v42, v43
  v_max3_f32 v14, v14, v36, v37
  v_max3_f32 v14, v14, v38, v39
  v_max3_f32 v14, v14, v40, v41
  v_max3_f32 v14, v14, v42, v43
  s_mov_b32 exec_lo, 0x00110011
  s_mov_b32 exec_hi, 0x00110011
  ds_write_b128 v12, v[100:103]
  s_mov_b64 exec, -1
  v_add_u32 v12, 128, v12
  s_add_u32 s77, s77, 1
  v_mov_b32 v35, s77
  ds_write_b32 v34, v35 offset:2368
  s_sub_u32 s87, s87, 1
  s_waitcnt vmcnt(24)
  v_mfma_f32_16x16x32_bf16 v[68:71], a[32:35], v[8:11], 0
  v_mfma_f32_16x16x32_bf16 v[72:75], a[36:39], v[8:11], 0
  v_mfma_f32_16x16x32_bf16 v[76:79], a[40:43], v[8:11], 0
  v_mfma_f32_16x16x32_bf16 v[80:83], a[44:47], v[8:11], 0
  v_mfma_f32_16x16x32_bf16 v[84:87], a[48:51], v[8:11], 0
  v_mfma_f32_16x16x32_bf16 v[88:91], a[52:55], v[8:11], 0
  v_mfma_f32_16x16x32_bf16 v[92:95], a[56:59], v[8:11], 0
  v_mfma_f32_16x16x32_bf16 v[96:99], a[60:63], v[8:11], 0
  buffer_load_dwordx4 a[32:35], v2, s[44:47], s70 offen offset:0 nt
  buffer_load_dwordx4 a[36:39], v2, s[44:47], s70 offen offset:1024 nt
  buffer_load_dwordx4 a[40:43], v2, s[44:47], s70 offen offset:2048 nt
  buffer_load_dwordx4 a[44:47], v2, s[44:47], s70 offen offset:3072 nt
  buffer_load_dwordx4 a[48:51], v3, s[44:47], s70 offen offset:0 nt
  buffer_load_dwordx4 a[52:55], v3, s[44:47], s70 offen offset:1024 nt
  buffer_load_dwordx4 a[56:59], v3, s[44:47], s70 offen offset:2048 nt
  buffer_load_dwordx4 a[60:63], v3, s[44:47], s70 offen offset:3072 nt
  s_add_u32 s70, s70, 16384
  s_sub_u32 s75, s75, 1
  v_mov_b32_dpp v36, v68 quad_perm:[0,0,0,0] row_mask:0xf bank_mask:0xf
  v_mov_b32_dpp v37, v72 quad_perm:[0,0,0,0] row_mask:0xf bank_mask:0xf
  v_mov_b32_dpp v38, v76 quad_perm:[0,0,0,0] row_mask:0xf bank_mask:0xf
  v_mov_b32_dpp v39, v80 quad_perm:[0,0,0,0] row_mask:0xf bank_mask:0xf
  v_mov_b32_dpp v40, v84 quad_perm:[0,0,0,0] row_mask:0xf bank_mask:0xf
  v_mov_b32_dpp v41, v88 quad_perm:[0,0,0,0] row_mask:0xf bank_mask:0xf
  v_mov_b32_dpp v42, v92 quad_perm:[0,0,0,0] row_mask:0xf bank_mask:0xf
  v_mov_b32_dpp v43, v96 quad_perm:[0,0,0,0] row_mask:0xf bank_mask:0xf
  v_add_f32_dpp v36, v69, v36 quad_perm:[1,1,1,1] row_mask:0xf bank_mask:0xf
  v_add_f32_dpp v37, v73, v37 quad_perm:[1,1,1,1] row_mask:0xf bank_mask:0xf
  v_add_f32_dpp v38, v77, v38 quad_perm:[1,1,1,1] row_mask:0xf bank_mask:0xf
  v_add_f32_dpp v39, v81, v39 quad_perm:[1,1,1,1] row_mask:0xf bank_mask:0xf
  v_add_f32_dpp v40, v85, v40 quad_perm:[1,1,1,1] row_mask:0xf bank_mask:0xf
  v_add_f32_dpp v41, v89, v41 quad_perm:[1,1,1,1] row_mask:0xf bank_mask:0xf
  v_add_f32_dpp v42, v93, v42 quad_perm:[1,1,1,1] row_mask:0xf bank_mask:0xf
  v_add_f32_dpp v43, v97, v43 quad_perm:[1,1,1,1] row_mask:0xf bank_mask:0xf
  v_add_f32_dpp v36, v70, v36 quad_perm:[2,2,2,2] row_mask:0xf bank_mask:0xf
  v_add_f32_dpp v37, v74, v37 quad_perm:[2,2,2,2] row_mask:0xf bank_mask:0xf
  v_add_f32_dpp v38, v78, v38 quad_perm:[2,2,2,2] row_mask:0xf bank_mask:0xf
  v_add_f32_dpp v39, v82, v39 quad_perm:[2,2,2,2] row_mask:0xf bank_mask:0xf
  v_add_f32_dpp v40, v86, v40 quad_perm:[2,2,2,2] row_mask:0xf bank_mask:0xf
  v_add_f32_dpp v41, v90, v41 quad_perm:[2,2,2,2] row_mask:0xf bank_mask:0xf
  v_add_f32_dpp v42, v94, v42 quad_perm:[2,2,2,2] row_mask:0xf bank_mask:0xf
  v_add_f32_dpp v43, v98, v43 quad_perm:[2,2,2,2] row_mask:0xf bank_mask:0xf
  v_add_f32_dpp v36, v71, v36 quad_perm:[3,3,3,3] row_mask:0xf bank_mask:0xf
  v_add_f32_dpp v37, v75, v37 quad_perm:[3,3,3,3] row_mask:0xf bank_mask:0xf
  v_add_f32_dpp v38, v79, v38 quad_perm:[3,3,3,3] row_mask:0xf bank_mask:0xf
  v_add_f32_dpp v39, v83, v39 quad_perm:[3,3,3,3] row_mask:0xf bank_mask:0xf
  v_add_f32_dpp v40, v87, v40 quad_perm:[3,3,3,3] row_mask:0xf bank_mask:0xf
  v_add_f32_dpp v41, v91, v41 quad_perm:[3,3,3,3] row_mask:0xf bank_mask:0xf
  v_add_f32_dpp v42, v95, v42 quad_perm:[3,3,3,3] row_mask:0xf bank_mask:0xf
  v_add_f32_dpp v43, v99, v43 quad_perm:[3,3,3,3] row_mask:0xf bank_mask:0xf
  v_cvt_pk_bf16_f32 v64, v36, v37
  v_cvt_pk_bf16_f32 v65, v38, v39
  v_cvt_pk_bf16_f32 v66, v40, v41
  v_cvt_pk_bf16_f32 v67, v42, v43
  v_lshlrev_b32 v36, 16, v64
  v_and_b32 v37, 0xffff0000, v64
  v_lshlrev_b32 v38, 16, v65
  v_and_b32 v39, 0xffff0000, v65
  v_lshlrev_b32 v40, 16, v66
  v_and_b32 v41, 0xffff0000, v66
  v_lshlrev_b32 v42, 16, v67
  v_and_b32 v43, 0xffff0000, v67
  v_mul_f32 v36, s72, v36
  v_mul_f32 v37, s72, v37
  v_mul_f32 v38, s72, v38
  v_mul_f32 v39, s72, v39
  v_mul_f32 v40, s72, v40
  v_mul_f32 v41, s72, v41
  v_mul_f32 v42, s72, v42
  v_mul_f32 v43, s72, v43
  v_cvt_pk_bf16_f32 v100, v36, v37
  v_cvt_pk_bf16_f32 v101, v38, v39
  v_cvt_pk_bf16_f32 v102, v40, v41
  v_cvt_pk_bf16_f32 v103, v42, v43
  v_max3_f32 v14, v14, v36, v37
  v_max3_f32 v14, v14, v38, v39
  v_max3_f32 v14, v14, v40, v41
  v_max3_f32 v14, v14, v42, v43
  s_mov_b32 exec_lo, 0x00110011
  s_mov_b32 exec_hi, 0x00110011
  ds_write_b128 v12, v[100:103]
  s_mov_b64 exec, -1
  v_add_u32 v12, 128, v12
  s_add_u32 s77, s77, 1
  v_mov_b32 v35, s77
  ds_write_b32 v34, v35 offset:2368
  s_sub_u32 s87, s87, 1
  s_waitcnt vmcnt(24)
  v_mfma_f32_16x16x32_bf16 v[68:71], a[64:67], v[8:11], 0
  v_mfma_f32_16x16x32_bf16 v[72:75], a[68:71], v[8:11], 0
  v_mfma_f32_16x16x32_bf16 v[76:79], a[72:75], v[8:11], 0
  v_mfma_f32_16x16x32_bf16 v[80:83], a[76:79], v[8:11], 0
  v_mfma_f32_16x16x32_bf16 v[84:87], a[80:83], v[8:11], 0
  v_mfma_f32_16x16x32_bf16 v[88:91], a[84:87], v[8:11], 0
  v_mfma_f32_16x16x32_bf16 v[92:95], a[88:91], v[8:11], 0
  v_mfma_f32_16x16x32_bf16 v[96:99], a[92:95], v[8:11], 0
  v_mov_b32_dpp v36, v68 quad_perm:[0,0,0,0] row_mask:0xf bank_mask:0xf
  v_mov_b32_dpp v37, v72 quad_perm:[0,0,0,0] row_mask:0xf bank_mask:0xf
  v_mov_b32_dpp v38, v76 quad_perm:[0,0,0,0] row_mask:0xf bank_mask:0xf
  v_mov_b32_dpp v39, v80 quad_perm:[0,0,0,0] row_mask:0xf bank_mask:0xf
  v_mov_b32_dpp v40, v84 quad_perm:[0,0,0,0] row_mask:0xf bank_mask:0xf
  v_mov_b32_dpp v41, v88 quad_perm:[0,0,0,0] row_mask:0xf bank_mask:0xf
  v_mov_b32_dpp v42, v92 quad_perm:[0,0,0,0] row_mask:0xf bank_mask:0xf
  v_mov_b32_dpp v43, v96 quad_perm:[0,0,0,0] row_mask:0xf bank_mask:0xf
  v_add_f32_dpp v36, v69, v36 quad_perm:[1,1,1,1] row_mask:0xf bank_mask:0xf
  v_add_f32_dpp v37, v73, v37 quad_perm:[1,1,1,1] row_mask:0xf bank_mask:0xf
  v_add_f32_dpp v38, v77, v38 quad_perm:[1,1,1,1] row_mask:0xf bank_mask:0xf
  v_add_f32_dpp v39, v81, v39 quad_perm:[1,1,1,1] row_mask:0xf bank_mask:0xf
  v_add_f32_dpp v40, v85, v40 quad_perm:[1,1,1,1] row_mask:0xf bank_mask:0xf
  v_add_f32_dpp v41, v89, v41 quad_perm:[1,1,1,1] row_mask:0xf bank_mask:0xf
  v_add_f32_dpp v42, v93, v42 quad_perm:[1,1,1,1] row_mask:0xf bank_mask:0xf
  v_add_f32_dpp v43, v97, v43 quad_perm:[1,1,1,1] row_mask:0xf bank_mask:0xf
  v_add_f32_dpp v36, v70, v36 quad_perm:[2,2,2,2] row_mask:0xf bank_mask:0xf
  v_add_f32_dpp v37, v74, v37 quad_perm:[2,2,2,2] row_mask:0xf bank_mask:0xf
  v_add_f32_dpp v38, v78, v38 quad_perm:[2,2,2,2] row_mask:0xf bank_mask:0xf
  v_add_f32_dpp v39, v82, v39 quad_perm:[2,2,2,2] row_mask:0xf bank_mask:0xf
  v_add_f32_dpp v40, v86, v40 quad_perm:[2,2,2,2] row_mask:0xf bank_mask:0xf
  v_add_f32_dpp v41, v90, v41 quad_perm:[2,2,2,2] row_mask:0xf bank_mask:0xf
  v_add_f32_dpp v42, v94, v42 quad_perm:[2,2,2,2] row_mask:0xf bank_mask:0xf
  v_add_f32_dpp v43, v98, v43 quad_perm:[2,2,2,2] row_mask:0xf bank_mask:0xf
  v_add_f32_dpp v36, v71, v36 quad_perm:[3,3,3,3] row_mask:0xf bank_mask:0xf
  v_add_f32_dpp v37, v75, v37 quad_perm:[3,3,3,3] row_mask:0xf bank_mask:0xf
  v_add_f32_dpp v38, v79, v38 quad_perm:[3,3,3,3] row_mask:0xf bank_mask:0xf
  v_add_f32_dpp v39, v83, v39 quad_perm:[3,3,3,3] row_mask:0xf bank_mask:0xf
  v_add_f32_dpp v40, v87, v40 quad_perm:[3,3,3,3] row_mask:0xf bank_mask:0xf
  v_add_f32_dpp v41, v91, v41 quad_perm:[3,3,3,3] row_mask:0xf bank_mask:0xf
  v_add_f32_dpp v42, v95, v42 quad_perm:[3,3,3,3] row_mask:0xf bank_mask:0xf
  v_add_f32_dpp v43, v99, v43 quad_perm:[3,3,3,3] row_mask:0xf bank_mask:0xf
  v_cvt_pk_bf16_f32 v64, v36, v37
  v_cvt_pk_bf16_f32 v65, v38, v39
  v_cvt_pk_bf16_f32 v66, v40, v41
  v_cvt_pk_bf16_f32 v67, v42, v43
  v_lshlrev_b32 v36, 16, v64
  v_and_b32 v37, 0xffff0000, v64
  v_lshlrev_b32 v38, 16, v65
  v_and_b32 v39, 0xffff0000, v65
  v_lshlrev_b32 v40, 16, v66
  v_and_b32 v41, 0xffff0000, v66
  v_lshlrev_b32 v42, 16, v67
  v_and_b32 v43, 0xffff0000, v67
  v_mul_f32 v36, s72, v36
  v_mul_f32 v37, s72, v37
  v_mul_f32 v38, s72, v38
  v_mul_f32 v39, s72, v39
  v_mul_f32 v40, s72, v40
  v_mul_f32 v41, s72, v41
  v_mul_f32 v42, s72, v42
  v_mul_f32 v43, s72, v43
  v_cvt_pk_bf16_f32 v100, v36, v37
  v_cvt_pk_bf16_f32 v101, v38, v39
  v_cvt_pk_bf16_f32 v102, v40, v41
  v_cvt_pk_bf16_f32 v103, v42, v43
  v_max3_f32 v14, v14, v36, v37
  v_max3_f32 v14, v14, v38, v39
  v_max3_f32 v14, v14, v40, v41
  v_max3_f32 v14, v14, v42, v43
  s_mov_b32 exec_lo, 0x00110011
  s_mov_b32 exec_hi, 0x00110011
  ds_write_b128 v12, v[100:103]
  s_mov_b64 exec, -1
  v_add_u32 v12, 128, v12
  s_add_u32 s77, s77, 1
  v_mov_b32 v35, s77
  ds_write_b32 v34, v35 offset:2368
  s_sub_u32 s87, s87, 1
  s_waitcnt vmcnt(16)
  v_mfma_f32_16x16x32_bf16 v[68:71], a[96:99], v[8:11], 0
  v_mfma_f32_16x16x32_bf16 v[72:75], a[100:103], v[8:11], 0
  v_mfma_f32_16x16x32_bf16 v[76:79], a[104:107], v[8:11], 0
  v_mfma_f32_16x16x32_bf16 v[80:83], a[108:111], v[8:11], 0
  v_mfma_f32_16x16x32_bf16 v[84:87], a[112:115], v[8:11], 0
  v_mfma_f32_16x16x32_bf16 v[88:91], a[116:119], v[8:11], 0
  v_mfma_f32_16x16x32_bf16 v[92:95], a[120:123], v[8:11], 0
  v_mfma_f32_16x16x32_bf16 v[96:99], a[124:127], v[8:11], 0
  v_mov_b32_dpp v36, v68 quad_perm:[0,0,0,0] row_mask:0xf bank_mask:0xf
  v_mov_b32_dpp v37, v72 quad_perm:[0,0,0,0] row_mask:0xf bank_mask:0xf
  v_mov_b32_dpp v38, v76 quad_perm:[0,0,0,0] row_mask:0xf bank_mask:0xf
  v_mov_b32_dpp v39, v80 quad_perm:[0,0,0,0] row_mask:0xf bank_mask:0xf
  v_mov_b32_dpp v40, v84 quad_perm:[0,0,0,0] row_mask:0xf bank_mask:0xf
  v_mov_b32_dpp v41, v88 quad_perm:[0,0,0,0] row_mask:0xf bank_mask:0xf
  v_mov_b32_dpp v42, v92 quad_perm:[0,0,0,0] row_mask:0xf bank_mask:0xf
  v_mov_b32_dpp v43, v96 quad_perm:[0,0,0,0] row_mask:0xf bank_mask:0xf
  v_add_f32_dpp v36, v69, v36 quad_perm:[1,1,1,1] row_mask:0xf bank_mask:0xf
  v_add_f32_dpp v37, v73, v37 quad_perm:[1,1,1,1] row_mask:0xf bank_mask:0xf
  v_add_f32_dpp v38, v77, v38 quad_perm:[1,1,1,1] row_mask:0xf bank_mask:0xf
  v_add_f32_dpp v39, v81, v39 quad_perm:[1,1,1,1] row_mask:0xf bank_mask:0xf
  v_add_f32_dpp v40, v85, v40 quad_perm:[1,1,1,1] row_mask:0xf bank_mask:0xf
  v_add_f32_dpp v41, v89, v41 quad_perm:[1,1,1,1] row_mask:0xf bank_mask:0xf
  v_add_f32_dpp v42, v93, v42 quad_perm:[1,1,1,1] row_mask:0xf bank_mask:0xf
  v_add_f32_dpp v43, v97, v43 quad_perm:[1,1,1,1] row_mask:0xf bank_mask:0xf
  v_add_f32_dpp v36, v70, v36 quad_perm:[2,2,2,2] row_mask:0xf bank_mask:0xf
  v_add_f32_dpp v37, v74, v37 quad_perm:[2,2,2,2] row_mask:0xf bank_mask:0xf
  v_add_f32_dpp v38, v78, v38 quad_perm:[2,2,2,2] row_mask:0xf bank_mask:0xf
  v_add_f32_dpp v39, v82, v39 quad_perm:[2,2,2,2] row_mask:0xf bank_mask:0xf
  v_add_f32_dpp v40, v86, v40 quad_perm:[2,2,2,2] row_mask:0xf bank_mask:0xf
  v_add_f32_dpp v41, v90, v41 quad_perm:[2,2,2,2] row_mask:0xf bank_mask:0xf
  v_add_f32_dpp v42, v94, v42 quad_perm:[2,2,2,2] row_mask:0xf bank_mask:0xf
  v_add_f32_dpp v43, v98, v43 quad_perm:[2,2,2,2] row_mask:0xf bank_mask:0xf
  v_add_f32_dpp v36, v71, v36 quad_perm:[3,3,3,3] row_mask:0xf bank_mask:0xf
  v_add_f32_dpp v37, v75, v37 quad_perm:[3,3,3,3] row_mask:0xf bank_mask:0xf
  v_add_f32_dpp v38, v79, v38 quad_perm:[3,3,3,3] row_mask:0xf bank_mask:0xf
  v_add_f32_dpp v39, v83, v39 quad_perm:[3,3,3,3] row_mask:0xf bank_mask:0xf
  v_add_f32_dpp v40, v87, v40 quad_perm:[3,3,3,3] row_mask:0xf bank_mask:0xf
  v_add_f32_dpp v41, v91, v41 quad_perm:[3,3,3,3] row_mask:0xf bank_mask:0xf
  v_add_f32_dpp v42, v95, v42 quad_perm:[3,3,3,3] row_mask:0xf bank_mask:0xf
  v_add_f32_dpp v43, v99, v43 quad_perm:[3,3,3,3] row_mask:0xf bank_mask:0xf
  v_cvt_pk_bf16_f32 v64, v36, v37
  v_cvt_pk_bf16_f32 v65, v38, v39
  v_cvt_pk_bf16_f32 v66, v40, v41
  v_cvt_pk_bf16_f32 v67, v42, v43
  v_lshlrev_b32 v36, 16, v64
  v_and_b32 v37, 0xffff0000, v64
  v_lshlrev_b32 v38, 16, v65
  v_and_b32 v39, 0xffff0000, v65
  v_lshlrev_b32 v40, 16, v66
  v_and_b32 v41, 0xffff0000, v66
  v_lshlrev_b32 v42, 16, v67
  v_and_b32 v43, 0xffff0000, v67
  v_mul_f32 v36, s72, v36
  v_mul_f32 v37, s72, v37
  v_mul_f32 v38, s72, v38
  v_mul_f32 v39, s72, v39
  v_mul_f32 v40, s72, v40
  v_mul_f32 v41, s72, v41
  v_mul_f32 v42, s72, v42
  v_mul_f32 v43, s72, v43
  v_cvt_pk_bf16_f32 v100, v36, v37
  v_cvt_pk_bf16_f32 v101, v38, v39
  v_cvt_pk_bf16_f32 v102, v40, v41
  v_cvt_pk_bf16_f32 v103, v42, v43
  v_max3_f32 v14, v14, v36, v37
  v_max3_f32 v14, v14, v38, v39
  v_max3_f32 v14, v14, v40, v41
  v_max3_f32 v14, v14, v42, v43
  s_mov_b32 exec_lo, 0x00110011
  s_mov_b32 exec_hi, 0x00110011
  ds_write_b128 v12, v[100:103]
  s_mov_b64 exec, -1
  v_add_u32 v12, 128, v12
  s_add_u32 s77, s77, 1
  v_mov_b32 v35, s77
  ds_write_b32 v34, v35 offset:2368
  s_sub_u32 s87, s87, 1
L_kloop:
L_k0:
  s_waitcnt vmcnt(8)
  v_mfma_f32_16x16x32_bf16 v[68:71], a[0:3], v[8:11], 0
  v_mfma_f32_16x16x32_bf16 v[72:75], a[4:7], v[8:11], 0
  v_mfma_f32_16x16x32_bf16 v[76:79], a[8:11], v[8:11], 0
  v_mfma_f32_16x16x32_bf16 v[80:83], a[12:15], v[8:11], 0
  v_mfma_f32_16x16x32_bf16 v[84:87], a[16:19], v[8:11], 0
  v_mfma_f32_16x16x32_bf16 v[88:91], a[20:23], v[8:11], 0
  v_mfma_f32_16x16x32_bf16 v[92:95], a[24:27], v[8:11], 0
  v_mfma_f32_16x16x32_bf16 v[96:99], a[28:31], v[8:11], 0
  s_cmp_eq_u32 s75, 0
  s_cbranch_scc1 L_kv_1
  buffer_load_dwordx4 a[0:3], v2, s[44:47], s70 offen offset:0 nt
  buffer_load_dwordx4 a[4:7], v2, s[44:47], s70 offen offset:1024 nt
  buffer_load_dwordx4 a[8:11], v2, s[44:47], s70 offen offset:2048 nt
  buffer_load_dwordx4 a[12:15], v2, s[44:47], s70 offen offset:3072 nt
  buffer_load_dwordx4 a[16:19], v3, s[44:47], s70 offen offset:0 nt
  buffer_load_dwordx4 a[20:23], v3, s[44:47], s70 offen offset:1024 nt
  buffer_load_dwordx4 a[24:27], v3, s[44:47], s70 offen offset:2048 nt
  buffer_load_dwordx4 a[28:31], v3, s[44:47], s70 offen offset:3072 nt
  s_add_u32 s70, s70, 16384
  s_sub_u32 s75, s75, 1
  s_branch L_kr_2
L_kv_1:
  buffer_load_dwordx4 a[0:3], v4, s[48:51], s71 offen offset:0 nt
  buffer_load_dwordx4 a[4:7], v4, s[48:51], s71 offen offset:1024 nt
  buffer_load_dwordx4 a[8:11], v4, s[48:51], s71 offen offset:2048 nt
  buffer_load_dwordx4 a[12:15], v4, s[48:51], s71 offen offset:3072 nt
  buffer_load_dwordx4 a[16:19], v5, s[48:51], s71 offen offset:0 nt
  buffer_load_dwordx4 a[20:23], v5, s[48:51], s71 offen offset:1024 nt
  buffer_load_dwordx4 a[24:27], v5, s[48:51], s71 offen offset:2048 nt
  buffer_load_dwordx4 a[28:31], v5, s[48:51], s71 offen offset:3072 nt
  s_add_u32 s71, s71, 16384
  s_sub_u32 s86, s86, 1
L_kr_2:
  v_mov_b32_dpp v36, v68 quad_perm:[0,0,0,0] row_mask:0xf bank_mask:0xf
  v_mov_b32_dpp v37, v72 quad_perm:[0,0,0,0] row_mask:0xf bank_mask:0xf
  v_mov_b32_dpp v38, v76 quad_perm:[0,0,0,0] row_mask:0xf bank_mask:0xf
  v_mov_b32_dpp v39, v80 quad_perm:[0,0,0,0] row_mask:0xf bank_mask:0xf
  v_mov_b32_dpp v40, v84 quad_perm:[0,0,0,0] row_mask:0xf bank_mask:0xf
  v_mov_b32_dpp v41, v88 quad_perm:[0,0,0,0] row_mask:0xf bank_mask:0xf
  v_mov_b32_dpp v42, v92 quad_perm:[0,0,0,0] row_mask:0xf bank_mask:0xf
  v_mov_b32_dpp v43, v96 quad_perm:[0,0,0,0] row_mask:0xf bank_mask:0xf
  v_add_f32_dpp v36, v69, v36 quad_perm:[1,1,1,1] row_mask:0xf bank_mask:0xf
  v_add_f32_dpp v37, v73, v37 quad_perm:[1,1,1,1] row_mask:0xf bank_mask:0xf
  v_add_f32_dpp v38, v77, v38 quad_perm:[1,1,1,1] row_mask:0xf bank_mask:0xf
  v_add_f32_dpp v39, v81, v39 quad_perm:[1,1,1,1] row_mask:0xf bank_mask:0xf
  v_add_f32_dpp v40, v85, v40 quad_perm:[1,1,1,1] row_mask:0xf bank_mask:0xf
  v_add_f32_dpp v41, v89, v41 quad_perm:[1,1,1,1] row_mask:0xf bank_mask:0xf
  v_add_f32_dpp v42, v93, v42 quad_perm:[1,1,1,1] row_mask:0xf bank_mask:0xf
  v_add_f32_dpp v43, v97, v43 quad_perm:[1,1,1,1] row_mask:0xf bank_mask:0xf
  v_add_f32_dpp v36, v70, v36 quad_perm:[2,2,2,2] row_mask:0xf bank_mask:0xf
  v_add_f32_dpp v37, v74, v37 quad_perm:[2,2,2,2] row_mask:0xf bank_mask:0xf
  v_add_f32_dpp v38, v78, v38 quad_perm:[2,2,2,2] row_mask:0xf bank_mask:0xf
  v_add_f32_dpp v39, v82, v39 quad_perm:[2,2,2,2] row_mask:0xf bank_mask:0xf
  v_add_f32_dpp v40, v86, v40 quad_perm:[2,2,2,2] row_mask:0xf bank_mask:0xf
  v_add_f32_dpp v41, v90, v41 quad_perm:[2,2,2,2] row_mask:0xf bank_mask:0xf
  v_add_f32_dpp v42, v94, v42 quad_perm:[2,2,2,2] row_mask:0xf bank_mask:0xf
  v_add_f32_dpp v43, v98, v43 quad_perm:[2,2,2,2] row_mask:0xf bank_mask:0xf
  v_add_f32_dpp v36, v71, v36 quad_perm:[3,3,3,3] row_mask:0xf bank_mask:0xf
  v_add_f32_dpp v37, v75, v37 quad_perm:[3,3,3,3] row_mask:0xf bank_mask:0xf
  v_add_f32_dpp v38, v79, v38 quad_perm:[3,3,3,3] row_mask:0xf bank_mask:0xf
  v_add_f32_dpp v39, v83, v39 quad_perm:[3,3,3,3] row_mask:0xf bank_mask:0xf
  v_add_f32_dpp v40, v87, v40 quad_perm:[3,3,3,3] row_mask:0xf bank_mask:0xf
  v_add_f32_dpp v41, v91, v41 quad_perm:[3,3,3,3] row_mask:0xf bank_mask:0xf
  v_add_f32_dpp v42, v95, v42 quad_perm:[3,3,3,3] row_mask:0xf bank_mask:0xf
  v_add_f32_dpp v43, v99, v43 quad_perm:[3,3,3,3] row_mask:0xf bank_mask:0xf
  v_cvt_pk_bf16_f32 v64, v36, v37
  v_cvt_pk_bf16_f32 v65, v38, v39
  v_cvt_pk_bf16_f32 v66, v40, v41
  v_cvt_pk_bf16_f32 v67, v42, v43
  v_lshlrev_b32 v36, 16, v64
  v_and_b32 v37, 0xffff0000, v64
  v_lshlrev_b32 v38, 16, v65
  v_and_b32 v39, 0xffff0000, v65
  v_lshlrev_b32 v40, 16, v66
  v_and_b32 v41, 0xffff0000, v66
  v_lshlrev_b32 v42, 16, v67
  v_and_b32 v43, 0xffff0000, v67
  v_mul_f32 v36, s72, v36
  v_mul_f32 v37, s72, v37
  v_mul_f32 v38, s72, v38
  v_mul_f32 v39, s72, v39
  v_mul_f32 v40, s72, v40
  v_mul_f32 v41, s72, v41
  v_mul_f32 v42, s72, v42
  v_mul_f32 v43, s72, v43
  v_cvt_pk_bf16_f32 v100, v36, v37
  v_cvt_pk_bf16_f32 v101, v38, v39
  v_cvt_pk_bf16_f32 v102, v40, v41
  v_cvt_pk_bf16_f32 v103, v42, v43
  v_max3_f32 v14, v14, v36, v37
  v_max3_f32 v14, v14, v38, v39
  v_max3_f32 v14, v14, v40, v41
  v_max3_f32 v14, v14, v42, v43
  s_mov_b32 exec_lo, 0x00110011
  s_mov_b32 exec_hi, 0x00110011
  ds_write_b128 v12, v[100:103]
  s_mov_b64 exec, -1
  v_add_u32 v12, 128, v12
  s_add_u32 s77, s77, 1
  v_mov_b32 v35, s77
  ds_write_b32 v34, v35 offset:2368
  s_sub_u32 s87, s87, 1
  s_cmp_eq_u32 s87, 0
  s_cselect_b32 s74, 1, s74
  s_cbranch_scc1 L_kdone
L_k1:
  s_waitcnt vmcnt(8)
  v_mfma_f32_16x16x32_bf16 v[68:71], a[32:35], v[8:11], 0
  v_mfma_f32_16x16x32_bf16 v[72:75], a[36:39], v[8:11], 0
  v_mfma_f32_16x16x32_bf16 v[76:79], a[40:43], v[8:11], 0
  v_mfma_f32_16x16x32_bf16 v[80:83], a[44:47], v[8:11], 0
  v_mfma_f32_16x16x32_bf16 v[84:87], a[48:51], v[8:11], 0
  v_mfma_f32_16x16x32_bf16 v[88:91], a[52:55], v[8:11], 0
  v_mfma_f32_16x16x32_bf16 v[92:95], a[56:59], v[8:11], 0
  v_mfma_f32_16x16x32_bf16 v[96:99], a[60:63], v[8:11], 0
  s_cmp_eq_u32 s75, 0
  s_cbranch_scc1 L_kv_3
  buffer_load_dwordx4 a[32:35], v2, s[44:47], s70 offen offset:0 nt
  buffer_load_dwordx4 a[36:39], v2, s[44:47], s70 offen offset:1024 nt
  buffer_load_dwordx4 a[40:43], v2, s[44:47], s70 offen offset:2048 nt
  buffer_load_dwordx4 a[44:47], v2, s[44:47], s70 offen offset:3072 nt
  buffer_load_dwordx4 a[48:51], v3, s[44:47], s70 offen offset:0 nt
  buffer_load_dwordx4 a[52:55], v3, s[44:47], s70 offen offset:1024 nt
  buffer_load_dwordx4 a[56:59], v3, s[44:47], s70 offen offset:2048 nt
  buffer_load_dwordx4 a[60:63], v3, s[44:47], s70 offen offset:3072 nt
  s_add_u32 s70, s70, 16384
  s_sub_u32 s75, s75, 1
  s_branch L_kr_4
L_kv_3:
  buffer_load_dwordx4 a[32:35], v4, s[48:51], s71 offen offset:0 nt
  buffer_load_dwordx4 a[36:39], v4, s[48:51], s71 offen offset:1024 nt
  buffer_load_dwordx4 a[40:43], v4, s[48:51], s71 offen offset:2048 nt
  buffer_load_dwordx4 a[44:47], v4, s[48:51], s71 offen offset:3072 nt
  buffer_load_dwordx4 a[48:51], v5, s[48:51], s71 offen offset:0 nt
  buffer_load_dwordx4 a[52:55], v5, s[48:51], s71 offen offset:1024 nt
  buffer_load_dwordx4 a[56:59], v5, s[48:51], s71 offen offset:2048 nt
  buffer_load_dwordx4 a[60:63], v5, s[48:51], s71 offen offset:3072 nt
  s_add_u32 s71, s71, 16384
  s_sub_u32 s86, s86, 1
L_kr_4:
  v_mov_b32_dpp v36, v68 quad_perm:[0,0,0,0] row_mask:0xf bank_mask:0xf
  v_mov_b32_dpp v37, v72 quad_perm:[0,0,0,0] row_mask:0xf bank_mask:0xf
  v_mov_b32_dpp v38, v76 quad_perm:[0,0,0,0] row_mask:0xf bank_mask:0xf
  v_mov_b32_dpp v39, v80 quad_perm:[0,0,0,0] row_mask:0xf bank_mask:0xf
  v_mov_b32_dpp v40, v84 quad_perm:[0,0,0,0] row_mask:0xf bank_mask:0xf
  v_mov_b32_dpp v41, v88 quad_perm:[0,0,0,0] row_mask:0xf bank_mask:0xf
  v_mov_b32_dpp v42, v92 quad_perm:[0,0,0,0] row_mask:0xf bank_mask:0xf
  v_mov_b32_dpp v43, v96 quad_perm:[0,0,0,0] row_mask:0xf bank_mask:0xf
  v_add_f32_dpp v36, v69, v36 quad_perm:[1,1,1,1] row_mask:0xf bank_mask:0xf
  v_add_f32_dpp v37, v73, v37 quad_perm:[1,1,1,1] row_mask:0xf bank_mask:0xf
  v_add_f32_dpp v38, v77, v38 quad_perm:[1,1,1,1] row_mask:0xf bank_mask:0xf
  v_add_f32_dpp v39, v81, v39 quad_perm:[1,1,1,1] row_mask:0xf bank_mask:0xf
  v_add_f32_dpp v40, v85, v40 quad_perm:[1,1,1,1] row_mask:0xf bank_mask:0xf
  v_add_f32_dpp v41, v89, v41 quad_perm:[1,1,1,1] row_mask:0xf bank_mask:0xf
  v_add_f32_dpp v42, v93, v42 quad_perm:[1,1,1,1] row_mask:0xf bank_mask:0xf
  v_add_f32_dpp v43, v97, v43 quad_perm:[1,1,1,1] row_mask:0xf bank_mask:0xf
  v_add_f32_dpp v36, v70, v36 quad_perm:[2,2,2,2] row_mask:0xf bank_mask:0xf
  v_add_f32_dpp v37, v74, v37 quad_perm:[2,2,2,2] row_mask:0xf bank_mask:0xf
  v_add_f32_dpp v38, v78, v38 quad_perm:[2,2,2,2] row_mask:0xf bank_mask:0xf
  v_add_f32_dpp v39, v82, v39 quad_perm:[2,2,2,2] row_mask:0xf bank_mask:0xf
  v_add_f32_dpp v40, v86, v40 quad_perm:[2,2,2,2] row_mask:0xf bank_mask:0xf
  v_add_f32_dpp v41, v90, v41 quad_perm:[2,2,2,2] row_mask:0xf bank_mask:0xf
  v_add_f32_dpp v42, v94, v42 quad_perm:[2,2,2,2] row_mask:0xf bank_mask:0xf
  v_add_f32_dpp v43, v98, v43 quad_perm:[2,2,2,2] row_mask:0xf bank_mask:0xf
  v_add_f32_dpp v36, v71, v36 quad_perm:[3,3,3,3] row_mask:0xf bank_mask:0xf
  v_add_f32_dpp v37, v75, v37 quad_perm:[3,3,3,3] row_mask:0xf bank_mask:0xf
  v_add_f32_dpp v38, v79, v38 quad_perm:[3,3,3,3] row_mask:0xf bank_mask:0xf
  v_add_f32_dpp v39, v83, v39 quad_perm:[3,3,3,3] row_mask:0xf bank_mask:0xf
  v_add_f32_dpp v40, v87, v40 quad_perm:[3,3,3,3] row_mask:0xf bank_mask:0xf
  v_add_f32_dpp v41, v91, v41 quad_perm:[3,3,3,3] row_mask:0xf bank_mask:0xf
  v_add_f32_dpp v42, v95, v42 quad_perm:[3,3,3,3] row_mask:0xf bank_mask:0xf
  v_add_f32_dpp v43, v99, v43 quad_perm:[3,3,3,3] row_mask:0xf bank_mask:0xf
  v_cvt_pk_bf16_f32 v64, v36, v37
  v_cvt_pk_bf16_f32 v65, v38, v39
  v_cvt_pk_bf16_f32 v66, v40, v41
  v_cvt_pk_bf16_f32 v67, v42, v43
  v_lshlrev_b32 v36, 16, v64
  v_and_b32 v37, 0xffff0000, v64
  v_lshlrev_b32 v38, 16, v65
  v_and_b32 v39, 0xffff0000, v65
  v_lshlrev_b32 v40, 16, v66
  v_and_b32 v41, 0xffff0000, v66
  v_lshlrev_b32 v42, 16, v67
  v_and_b32 v43, 0xffff0000, v67
  v_mul_f32 v36, s72, v36
  v_mul_f32 v37, s72, v37
  v_mul_f32 v38, s72, v38
  v_mul_f32 v39, s72, v39
  v_mul_f32 v40, s72, v40
  v_mul_f32 v41, s72, v41
  v_mul_f32 v42, s72, v42
  v_mul_f32 v43, s72, v43
  v_cvt_pk_bf16_f32 v100, v36, v37
  v_cvt_pk_bf16_f32 v101, v38, v39
  v_cvt_pk_bf16_f32 v102, v40, v41
  v_cvt_pk_bf16_f32 v103, v42, v43
  v_max3_f32 v14, v14, v36, v37
  v_max3_f32 v14, v14, v38, v39
  v_max3_f32 v14, v14, v40, v41
  v_max3_f32 v14, v14, v42, v43
  s_mov_b32 exec_lo, 0x00110011
  s_mov_b32 exec_hi, 0x00110011
  ds_write_b128 v12, v[100:103]
  s_mov_b64 exec, -1
  v_add_u32 v12, 128, v12
  s_add_u32 s77, s77, 1
  v_mov_b32 v35, s77
  ds_write_b32 v34, v35 offset:2368
  s_sub_u32 s87, s87, 1
  s_cmp_eq_u32 s87, 0
  s_cselect_b32 s74, 0, s74
  s_cbranch_scc0 L_kloop
L_kdone:
  v_cvt_pk_bf16_f32 v32, v14, v14
  v_and_b32 v32, 0xffff0000, v32
  v_mul_f32 v32, s73, v32
  v_mov_b32 v64, v32
  s_nop 1
  v_permlane16_swap_b32 v32, v64
  v_max_f32 v32, v32, v64
  v_mov_b32 v64, v32
  s_nop 1
  v_permlane32_swap_b32 v32, v64
  v_max_f32 v32, v32, v64
  s_waitcnt lgkmcnt(0)
  s_cmp_lg_u32 s74, 0
  s_cbranch_scc1 L_kn_5
  ds_read_b128 v[16:19], v13
  s_branch L_v0
L_kn_5:
  s_cmp_lg_u32 s74, 1
  s_cbranch_scc1 L_kn_6
  ds_read_b128 v[20:23], v13
  s_branch L_v1
L_kn_6:
L_vloop:
L_v0:
  s_waitcnt lgkmcnt(0)
  ds_read_b128 v[20:23], v13 offset:128
  v_add_u32 v13, 128, v13
  v_lshlrev_b32 v36, 16, v16
  v_and_b32 v37, 0xffff0000, v16
  v_lshlrev_b32 v38, 16, v17
  v_and_b32 v39, 0xffff0000, v17
  v_lshlrev_b32 v40, 16, v18
  v_and_b32 v41, 0xffff0000, v18
  v_lshlrev_b32 v42, 16, v19
  v_and_b32 v43, 0xffff0000, v19
  v_fma_f32 v44, v36, s73, -v32
  v_fma_f32 v45, v37, s73, -v32
  v_fma_f32 v46, v38, s73, -v32
  v_fma_f32 v47, v39, s73, -v32
  v_fma_f32 v48, v40, s73, -v32
  v_fma_f32 v49, v41, s73, -v32
  v_fma_f32 v50, v42, s73, -v32
  v_fma_f32 v51, v43, s73, -v32
  v_exp_f32 v44, v44
  v_exp_f32 v45, v45
  v_exp_f32 v46, v46
  v_exp_f32 v47, v47
  v_exp_f32 v48, v48
  v_exp_f32 v49, v49
  v_exp_f32 v50, v50
  v_exp_f32 v51, v51
  v_cvt_pk_bf16_f32 v66, v44, v44
  v_and_b32 v52, v66, v24
  v_and_b32 v53, v66, v25
  v_and_b32 v54, v66, v26
  v_and_b32 v55, v66, v27
  v_cvt_pk_bf16_f32 v66, v45, v45
  v_and_b32 v56, v66, v24
  v_and_b32 v57, v66, v25
  v_and_b32 v58, v66, v26
  v_and_b32 v59, v66, v27
  v_add_f32 v64, v44, v45
  v_add_f32 v65, v46, v47
  s_waitcnt vmcnt(8)
  v_mfma_f32_16x16x32_bf16 v[28:31], a[0:3], v[52:55], v[28:31]
  v_cvt_pk_bf16_f32 v66, v46, v46
  v_and_b32 v60, v66, v24
  v_and_b32 v61, v66, v25
  v_and_b32 v62, v66, v26
  v_and_b32 v63, v66, v27
  v_mfma_f32_16x16x32_bf16 v[28:31], a[4:7], v[56:59], v[28:31]
  v_cvt_pk_bf16_f32 v66, v47, v47
  v_and_b32 v52, v66, v24
  v_and_b32 v53, v66, v25
  v_and_b32 v54, v66, v26
  v_and_b32 v55, v66, v27
  v_add_f32 v64, v64, v48
  v_add_f32 v65, v65, v49
  v_mfma_f32_16x16x32_bf16 v[28:31], a[8:11], v[60:63], v[28:31]
  v_cvt_pk_bf16_f32 v66, v48, v48
  v_and_b32 v56, v66, v24
  v_and_b32 v57, v66, v25
  v_and_b32 v58, v66, v26
  v_and_b32 v59, v66, v27
  v_add_f32 v64, v64, v50
  v_add_f32 v65, v65, v51
  v_mfma_f32_16x16x32_bf16 v[28:31], a[12:15], v[52:55], v[28:31]
  v_cvt_pk_bf16_f32 v66, v49, v49
  v_and_b32 v60, v66, v24
  v_and_b32 v61, v66, v25
  v_and_b32 v62, v66, v26
  v_and_b32 v63, v66, v27
  v_add_f32 v64, v64, v65
  v_add_f32 v33, v33, v64
  v_mfma_f32_16x16x32_bf16 v[28:31], a[16:19], v[56:59], v[28:31]
  v_cvt_pk_bf16_f32 v66, v50, v50
  v_and_b32 v52, v66, v24
  v_and_b32 v53, v66, v25
  v_and_b32 v54, v66, v26
  v_and_b32 v55, v66, v27
  v_mfma_f32_16x16x32_bf16 v[28:31], a[20:23], v[60:63], v[28:31]
  v_cvt_pk_bf16_f32 v66, v51, v51
  v_and_b32 v56, v66, v24
  v_and_b32 v57, v66, v25
  v_and_b32 v58, v66, v26
  v_and_b32 v59, v66, v27
  v_mfma_f32_16x16x32_bf16 v[28:31], a[24:27], v[52:55], v[28:31]
  s_nop 0
  v_mfma_f32_16x16x32_bf16 v[28:31], a[28:31], v[56:59], v[28:31]
  s_cmp_eq_u32 s86, 0
  s_cbranch_scc1 L_vp_7
  buffer_load_dwordx4 a[0:3], v4, s[48:51], s71 offen offset:0 nt
  buffer_load_dwordx4 a[4:7], v4, s[48:51], s71 offen offset:1024 nt
  buffer_load_dwordx4 a[8:11], v4, s[48:51], s71 offen offset:2048 nt
  buffer_load_dwordx4 a[12:15], v4, s[48:51], s71 offen offset:3072 nt
  buffer_load_dwordx4 a[16:19], v5, s[48:51], s71 offen offset:0 nt
  buffer_load_dwordx4 a[20:23], v5, s[48:51], s71 offen offset:1024 nt
  buffer_load_dwordx4 a[24:27], v5, s[48:51], s71 offen offset:2048 nt
  buffer_load_dwordx4 a[28:31], v5, s[48:51], s71 offen offset:3072 nt
  s_add_u32 s71, s71, 16384
  s_sub_u32 s86, s86, 1
  s_branch L_vr_8
L_vp_7:
  s_waitcnt lgkmcnt(0)
  s_cmp_lt_u32 s76, 128
  s_cbranch_scc0 L_dead_9
  s_cmp_lt_u32 s76, 128
  s_cbranch_scc0 L_half_11
  s_add_u32 s67, s76, 896
  s_lshl_b32 s67, s67, 13
  s_mov_b32 s81, 4096
  s_branch L_claim_12
L_half_11:
  s_add_u32 s67, s76, 1920
  s_lshl_b32 s67, s67, 12
  s_mov_b32 s81, 0x40000000
L_claim_12:
  s_add_u32 s89, s89, 1
  s_mov_b32 s76, 1
  s_atomic_add s76, s[78:79], 0 glc
  s_branch L_go_10
L_dead_9:
  s_mov_b32 s46, 0
  s_mov_b32 s50, 0
  s_mov_b32 s67, 0
  s_mov_b32 s81, 4096
L_go_10:
  v_add_u32 v104, s81, v2
  buffer_load_dwordx4 a[0:3], v2, s[44:47], s67 offen offset:0 nt
  buffer_load_dwordx4 a[4:7], v2, s[44:47], s67 offen offset:1024 nt
  buffer_load_dwordx4 a[8:11], v2, s[44:47], s67 offen offset:2048 nt
  buffer_load_dwordx4 a[12:15], v2, s[44:47], s67 offen offset:3072 nt
  buffer_load_dwordx4 a[16:19], v104, s[44:47], s67 offen offset:0 nt
  buffer_load_dwordx4 a[20:23], v104, s[44:47], s67 offen offset:1024 nt
  buffer_load_dwordx4 a[24:27], v104, s[44:47], s67 offen offset:2048 nt
  buffer_load_dwordx4 a[28:31], v104, s[44:47], s67 offen offset:3072 nt
L_vr_8:
  s_add_u32 s77, s77, 1
  v_mov_b32 v35, s77
  ds_write_b32 v34, v35 offset:2368
  s_sub_u32 s88, s88, 1
L_v1:
  s_waitcnt lgkmcnt(0)
  ds_read_b128 v[16:19], v13 offset:128
  v_add_u32 v13, 128, v13
  v_lshlrev_b32 v36, 16, v20
  v_and_b32 v37, 0xffff0000, v20
  v_lshlrev_b32 v38, 16, v21
  v_and_b32 v39, 0xffff0000, v21
  v_lshlrev_b32 v40, 16, v22
  v_and_b32 v41, 0xffff0000, v22
  v_lshlrev_b32 v42, 16, v23
  v_and_b32 v43, 0xffff0000, v23
  v_fma_f32 v44, v36, s73, -v32
  v_fma_f32 v45, v37, s73, -v32
  v_fma_f32 v46, v38, s73, -v32
  v_fma_f32 v47, v39, s73, -v32
  v_fma_f32 v48, v40, s73, -v32
  v_fma_f32 v49, v41, s73, -v32
  v_fma_f32 v50, v42, s73, -v32
  v_fma_f32 v51, v43, s73, -v32
  v_exp_f32 v44, v44
  v_exp_f32 v45, v45
  v_exp_f32 v46, v46
  v_exp_f32 v47, v47
  v_exp_f32 v48, v48
  v_exp_f32 v49, v49
  v_exp_f32 v50, v50
  v_exp_f32 v51, v51
  v_cvt_pk_bf16_f32 v66, v44, v44
  v_and_b32 v52, v66, v24
  v_and_b32 v53, v66, v25
  v_and_b32 v54, v66, v26
  v_and_b32 v55, v66, v27
  v_cvt_pk_bf16_f32 v66, v45, v45
  v_and_b32 v56, v66, v24
  v_and_b32 v57, v66, v25
  v_and_b32 v58, v66, v26
  v_and_b32 v59, v66, v27
  v_add_f32 v64, v44, v45
  v_add_f32 v65, v46, v47
  s_waitcnt vmcnt(8)
  v_mfma_f32_16x16x32_bf16 v[28:31], a[32:35], v[52:55], v[28:31]
  v_cvt_pk_bf16_f32 v66, v46, v46
  v_and_b32 v60, v66, v24
  v_and_b32 v61, v66, v25
  v_and_b32 v62, v66, v26
  v_and_b32 v63, v66, v27
  v_mfma_f32_16x16x32_bf16 v[28:31], a[36:39], v[56:59], v[28:31]
  v_cvt_pk_bf16_f32 v66, v47, v47
  v_and_b32 v52, v66, v24
  v_and_b32 v53, v66, v25
  v_and_b32 v54, v66, v26
  v_and_b32 v55, v66, v27
  v_add_f32 v64, v64, v48
  v_add_f32 v65, v65, v49
  v_mfma_f32_16x16x32_bf16 v[28:31], a[40:43], v[60:63], v[28:31]
  v_cvt_pk_bf16_f32 v66, v48, v48
  v_and_b32 v56, v66, v24
  v_and_b32 v57, v66, v25
  v_and_b32 v58, v66, v26
  v_and_b32 v59, v66, v27
  v_add_f32 v64, v64, v50
  v_add_f32 v65, v65, v51
  v_mfma_f32_16x16x32_bf16 v[28:31], a[44:47], v[52:55], v[28:31]
  v_cvt_pk_bf16_f32 v66, v49, v49
  v_and_b32 v60, v66, v24
  v_and_b32 v61, v66, v25
  v_and_b32 v62, v66, v26
  v_and_b32 v63, v66, v27
  v_add_f32 v64, v64, v65
  v_add_f32 v33, v33, v64
  v_mfma_f32_16x16x32_bf16 v[28:31], a[48:51], v[56:59], v[28:31]
  v_cvt_pk_bf16_f32 v66, v50, v50
  v_and_b32 v52, v66, v24
  v_and_b32 v53, v66, v25
  v_and_b32 v54, v66, v26
  v_and_b32 v55, v66, v27
  v_mfma_f32_16x16x32_bf16 v[28:31], a[52:55], v[60:63], v[28:31]
  v_cvt_pk_bf16_f32 v66, v51, v51
  v_and_b32 v56, v66, v24
  v_and_b32 v57, v66, v25
  v_and_b32 v58, v66, v26
  v_and_b32 v59, v66, v27
  v_mfma_f32_16x16x32_bf16 v[28:31], a[56:59], v[52:55], v[28:31]
  s_nop 0
  v_mfma_f32_16x16x32_bf16 v[28:31], a[60:63], v[56:59], v[28:31]
  s_cmp_eq_u32 s86, 0
  s_cbranch_scc1 L_vp_13
  buffer_load_dwordx4 a[32:35], v4, s[48:51], s71 offen offset:0 nt
  buffer_load_dwordx4 a[36:39], v4, s[48:51], s71 offen offset:1024 nt
  buffer_load_dwordx4 a[40:43], v4, s[48:51], s71 offen offset:2048 nt
  buffer_load_dwordx4 a[44:47], v4, s[48:51], s71 offen offset:3072 nt
  buffer_load_dwordx4 a[48:51], v5, s[48:51], s71 offen offset:0 nt
  buffer_load_dwordx4 a[52:55], v5, s[48:51], s71 offen offset:1024 nt
  buffer_load_dwordx4 a[56:59], v5, s[48:51], s71 offen offset:2048 nt
  buffer_load_dwordx4 a[60:63], v5, s[48:51], s71 offen offset:3072 nt
  s_add_u32 s71, s71, 16384
  s_sub_u32 s86, s86, 1
  s_branch L_vr_14
L_vp_13:
  v_add_u32 v105, s81, v4
  buffer_load_dwordx4 a[32:35], v4, s[48:51], s67 offen offset:0 nt
  buffer_load_dwordx4 a[36:39], v4, s[48:51], s67 offen offset:1024 nt
  buffer_load_dwordx4 a[40:43], v4, s[48:51], s67 offen offset:2048 nt
  buffer_load_dwordx4 a[44:47], v4, s[48:51], s67 offen offset:3072 nt
  buffer_load_dwordx4 a[48:51], v105, s[48:51], s67 offen offset:0 nt
  buffer_load_dwordx4 a[52:55], v105, s[48:51], s67 offen offset:1024 nt
  buffer_load_dwordx4 a[56:59], v105, s[48:51], s67 offen offset:2048 nt
  buffer_load_dwordx4 a[60:63], v105, s[48:51], s67 offen offset:3072 nt
L_vr_14:
  s_add_u32 s77, s77, 1
  v_mov_b32 v35, s77
  ds_write_b32 v34, v35 offset:2368
  s_sub_u32 s88, s88, 1
  s_cmp_eq_u32 s88, 0
  s_cbranch_scc1 L_p0
  s_branch L_vloop
L_ploop:
L_p0:
  s_cmp_eq_u32 s89, 0
  s_cbranch_scc1 L_att_done
  s_sub_u32 s89, s89, 1
  s_waitcnt vmcnt(8)
  v_mfma_f32_16x16x32_bf16 v[68:71], a[0:3], v[8:11], 0
  v_mfma_f32_16x16x32_bf16 v[72:75], a[4:7], v[8:11], 0
  v_mfma_f32_16x16x32_bf16 v[76:79], a[8:11], v[8:11], 0
  v_mfma_f32_16x16x32_bf16 v[80:83], a[12:15], v[8:11], 0
  v_mfma_f32_16x16x32_bf16 v[84:87], a[16:19], v[8:11], 0
  v_mfma_f32_16x16x32_bf16 v[88:91], a[20:23], v[8:11], 0
  v_mfma_f32_16x16x32_bf16 v[92:95], a[24:27], v[8:11], 0
  v_mfma_f32_16x16x32_bf16 v[96:99], a[28:31], v[8:11], 0
  s_mov_b32 s85, s81
  s_waitcnt lgkmcnt(0)
  s_cmp_lt_u32 s76, 128
  s_cbranch_scc0 L_dead_15
  s_cmp_lt_u32 s76, 128
  s_cbranch_scc0 L_half_17
  s_add_u32 s67, s76, 896
  s_lshl_b32 s67, s67, 13
  s_mov_b32 s81, 4096
  s_branch L_claim_18
L_half_17:
  s_add_u32 s67, s76, 1920
  s_lshl_b32 s67, s67, 12
  s_mov_b32 s81, 0x40000000
L_claim_18:
  s_add_u32 s89, s89, 1
  s_mov_b32 s76, 1
  s_atomic_add s76, s[78:79], 0 glc
  s_branch L_go_16
L_dead_15:
  s_mov_b32 s46, 0
  s_mov_b32 s50, 0
  s_mov_b32 s67, 0
  s_mov_b32 s81, 4096
L_go_16:
  v_add_u32 v104, s81, v2
  buffer_load_dwordx4 a[0:3], v2, s[44:47], s67 offen offset:0 nt
  buffer_load_dwordx4 a[4:7], v2, s[44:47], s67 offen offset:1024 nt
  buffer_load_dwordx4 a[8:11], v2, s[44:47], s67 offen offset:2048 nt
  buffer_load_dwordx4 a[12:15], v2, s[44:47], s67 offen offset:3072 nt
  buffer_load_dwordx4 a[16:19], v104, s[44:47], s67 offen offset:0 nt
  buffer_load_dwordx4 a[20:23], v104, s[44:47], s67 offen offset:1024 nt
  buffer_load_dwordx4 a[24:27], v104, s[44:47], s67 offen offset:2048 nt
  buffer_load_dwordx4 a[28:31], v104, s[44:47], s67 offen offset:3072 nt
  v_mov_b32_dpp v36, v68 quad_perm:[0,0,0,0] row_mask:0xf bank_mask:0xf
  v_mov_b32_dpp v37, v72 quad_perm:[0,0,0,0] row_mask:0xf bank_mask:0xf
  v_mov_b32_dpp v38, v76 quad_perm:[0,0,0,0] row_mask:0xf bank_mask:0xf
  v_mov_b32_dpp v39, v80 quad_perm:[0,0,0,0] row_mask:0xf bank_mask:0xf
  v_mov_b32_dpp v40, v84 quad_perm:[0,0,0,0] row_mask:0xf bank_mask:0xf
  v_mov_b32_dpp v41, v88 quad_perm:[0,0,0,0] row_mask:0xf bank_mask:0xf
  v_mov_b32_dpp v42, v92 quad_perm:[0,0,0,0] row_mask:0xf bank_mask:0xf
  v_mov_b32_dpp v43, v96 quad_perm:[0,0,0,0] row_mask:0xf bank_mask:0xf
  v_add_f32_dpp v36, v69, v36 quad_perm:[1,1,1,1] row_mask:0xf bank_mask:0xf
  v_add_f32_dpp v37, v73, v37 quad_perm:[1,1,1,1] row_mask:0xf bank_mask:0xf
  v_add_f32_dpp v38, v77, v38 quad_perm:[1,1,1,1] row_mask:0xf bank_mask:0xf
  v_add_f32_dpp v39, v81, v39 quad_perm:[1,1,1,1] row_mask:0xf bank_mask:0xf
  v_add_f32_dpp v40, v85, v40 quad_perm:[1,1,1,1] row_mask:0xf bank_mask:0xf
  v_add_f32_dpp v41, v89, v41 quad_perm:[1,1,1,1] row_mask:0xf bank_mask:0xf
  v_add_f32_dpp v42, v93, v42 quad_perm:[1,1,1,1] row_mask:0xf bank_mask:0xf
  v_add_f32_dpp v43, v97, v43 quad_perm:[1,1,1,1] row_mask:0xf bank_mask:0xf
  v_add_f32_dpp v36, v70, v36 quad_perm:[2,2,2,2] row_mask:0xf bank_mask:0xf
  v_add_f32_dpp v37, v74, v37 quad_perm:[2,2,2,2] row_mask:0xf bank_mask:0xf
  v_add_f32_dpp v38, v78, v38 quad_perm:[2,2,2,2] row_mask:0xf bank_mask:0xf
  v_add_f32_dpp v39, v82, v39 quad_perm:[2,2,2,2] row_mask:0xf bank_mask:0xf
  v_add_f32_dpp v40, v86, v40 quad_perm:[2,2,2,2] row_mask:0xf bank_mask:0xf
  v_add_f32_dpp v41, v90, v41 quad_perm:[2,2,2,2] row_mask:0xf bank_mask:0xf
  v_add_f32_dpp v42, v94, v42 quad_perm:[2,2,2,2] row_mask:0xf bank_mask:0xf
  v_add_f32_dpp v43, v98, v43 quad_perm:[2,2,2,2] row_mask:0xf bank_mask:0xf
  v_add_f32_dpp v36, v71, v36 quad_perm:[3,3,3,3] row_mask:0xf bank_mask:0xf
  v_add_f32_dpp v37, v75, v37 quad_perm:[3,3,3,3] row_mask:0xf bank_mask:0xf
  v_add_f32_dpp v38, v79, v38 quad_perm:[3,3,3,3] row_mask:0xf bank_mask:0xf
  v_add_f32_dpp v39, v83, v39 quad_perm:[3,3,3,3] row_mask:0xf bank_mask:0xf
  v_add_f32_dpp v40, v87, v40 quad_perm:[3,3,3,3] row_mask:0xf bank_mask:0xf
  v_add_f32_dpp v41, v91, v41 quad_perm:[3,3,3,3] row_mask:0xf bank_mask:0xf
  v_add_f32_dpp v42, v95, v42 quad_perm:[3,3,3,3] row_mask:0xf bank_mask:0xf
  v_add_f32_dpp v43, v99, v43 quad_perm:[3,3,3,3] row_mask:0xf bank_mask:0xf
  v_cvt_pk_bf16_f32 v64, v36, v37
  v_cvt_pk_bf16_f32 v65, v38, v39
  v_cvt_pk_bf16_f32 v66, v40, v41
  v_cvt_pk_bf16_f32 v67, v42, v43
  v_lshlrev_b32 v36, 16, v64
  v_and_b32 v37, 0xffff0000, v64
  v_lshlrev_b32 v38, 16, v65
  v_and_b32 v39, 0xffff0000, v65
  v_lshlrev_b32 v40, 16, v66
  v_and_b32 v41, 0xffff0000, v66
  v_lshlrev_b32 v42, 16, v67
  v_and_b32 v43, 0xffff0000, v67
  v_mul_f32 v36, s72, v36
  v_mul_f32 v37, s72, v37
  v_mul_f32 v38, s72, v38
  v_mul_f32 v39, s72, v39
  v_mul_f32 v40, s72, v40
  v_mul_f32 v41, s72, v41
  v_mul_f32 v42, s72, v42
  v_mul_f32 v43, s72, v43
  v_cvt_pk_bf16_f32 v100, v36, v37
  v_cvt_pk_bf16_f32 v101, v38, v39
  v_cvt_pk_bf16_f32 v102, v40, v41
  v_cvt_pk_bf16_f32 v103, v42, v43
  v_lshlrev_b32 v36, 16, v100
  v_and_b32 v37, 0xffff0000, v100
  v_lshlrev_b32 v38, 16, v101
  v_and_b32 v39, 0xffff0000, v101
  v_lshlrev_b32 v40, 16, v102
  v_and_b32 v41, 0xffff0000, v102
  v_lshlrev_b32 v42, 16, v103
  v_and_b32 v43, 0xffff0000, v103
  s_cmp_eq_u32 s85, 4096
  s_cbranch_scc1 L_full_19
  v_mov_b32 v40, 0xff800000
  v_mov_b32 v41, 0xff800000
  v_mov_b32 v42, 0xff800000
  v_mov_b32 v43, 0xff800000
L_full_19:
  v_max3_f32 v64, v36, v37, v38
  v_max3_f32 v64, v64, v39, v40
  v_max3_f32 v64, v64, v41, v42
  v_max_f32 v64, v64, v43
  v_mul_f32 v64, s73, v64
  v_cmp_gt_f32 vcc, v64, v32
  s_cbranch_vccz L_nomax_20
  v_mov_b32 v65, v64
  s_nop 1
  v_permlane16_swap_b32 v64, v65
  v_max_f32 v64, v64, v65
  v_mov_b32 v65, v64
  s_nop 1
  v_permlane32_swap_b32 v64, v65
  v_max_f32 v64, v64, v65
  v_max_f32 v64, v64, v32
  v_sub_f32 v65, v32, v64
  v_exp_f32 v65, v65
  v_mov_b32 v32, v64
  v_mul_f32 v28, v28, v65
  v_mul_f32 v29, v29, v65
  v_mul_f32 v30, v30, v65
  v_mul_f32 v31, v31, v65
  v_mul_f32 v33, v33, v65
L_nomax_20:
  v_fma_f32 v44, v36, s73, -v32
  v_fma_f32 v45, v37, s73, -v32
  v_fma_f32 v46, v38, s73, -v32
  v_fma_f32 v47, v39, s73, -v32
  v_fma_f32 v48, v40, s73, -v32
  v_fma_f32 v49, v41, s73, -v32
  v_fma_f32 v50, v42, s73, -v32
  v_fma_f32 v51, v43, s73, -v32
  v_exp_f32 v44, v44
  v_exp_f32 v45, v45
  v_exp_f32 v46, v46
  v_exp_f32 v47, v47
  v_exp_f32 v48, v48
  v_exp_f32 v49, v49
  v_exp_f32 v50, v50
  v_exp_f32 v51, v51
  v_cvt_pk_bf16_f32 v66, v44, v44
  v_and_b32 v52, v66, v24
  v_and_b32 v53, v66, v25
  v_and_b32 v54, v66, v26
  v_and_b32 v55, v66, v27
  v_cvt_pk_bf16_f32 v66, v45, v45
  v_and_b32 v56, v66, v24
  v_and_b32 v57, v66, v25
  v_and_b32 v58, v66, v26
  v_and_b32 v59, v66, v27
  v_add_f32 v64, v44, v45
  v_add_f32 v65, v46, v47
  s_waitcnt vmcnt(8)
  v_mfma_f32_16x16x32_bf16 v[28:31], a[32:35], v[52:55], v[28:31]
  v_cvt_pk_bf16_f32 v66, v46, v46
  v_and_b32 v60, v66, v24
  v_and_b32 v61, v66, v25
  v_and_b32 v62, v66, v26
  v_and_b32 v63, v66, v27
  v_mfma_f32_16x16x32_bf16 v[28:31], a[36:39], v[56:59], v[28:31]
  v_cvt_pk_bf16_f32 v66, v47, v47
  v_and_b32 v52, v66, v24
  v_and_b32 v53, v66, v25
  v_and_b32 v54, v66, v26
  v_and_b32 v55, v66, v27
  v_add_f32 v64, v64, v48
  v_add_f32 v65, v65, v49
  v_mfma_f32_16x16x32_bf16 v[28:31], a[40:43], v[60:63], v[28:31]
  v_cvt_pk_bf16_f32 v66, v48, v48
  v_and_b32 v56, v66, v24
  v_and_b32 v57, v66, v25
  v_and_b32 v58, v66, v26
  v_and_b32 v59, v66, v27
  v_add_f32 v64, v64, v50
  v_add_f32 v65, v65, v51
  v_mfma_f32_16x16x32_bf16 v[28:31], a[44:47], v[52:55], v[28:31]
  v_cvt_pk_bf16_f32 v66, v49, v49
  v_and_b32 v60, v66, v24
  v_and_b32 v61, v66, v25
  v_and_b32 v62, v66, v26
  v_and_b32 v63, v66, v27
  v_add_f32 v64, v64, v65
  v_add_f32 v33, v33, v64
  v_mfma_f32_16x16x32_bf16 v[28:31], a[48:51], v[56:59], v[28:31]
  v_cvt_pk_bf16_f32 v66, v50, v50
  v_and_b32 v52, v66, v24
  v_and_b32 v53, v66, v25
  v_and_b32 v54, v66, v26
  v_and_b32 v55, v66, v27
  v_mfma_f32_16x16x32_bf16 v[28:31], a[52:55], v[60:63], v[28:31]
  v_cvt_pk_bf16_f32 v66, v51, v51
  v_and_b32 v56, v66, v24
  v_and_b32 v57, v66, v25
  v_and_b32 v58, v66, v26
  v_and_b32 v59, v66, v27
  v_mfma_f32_16x16x32_bf16 v[28:31], a[56:59], v[52:55], v[28:31]
  s_nop 0
  v_mfma_f32_16x16x32_bf16 v[28:31], a[60:63], v[56:59], v[28:31]
  v_add_u32 v105, s81, v4
  buffer_load_dwordx4 a[32:35], v4, s[48:51], s67 offen offset:0 nt
  buffer_load_dwordx4 a[36:39], v4, s[48:51], s67 offen offset:1024 nt
  buffer_load_dwordx4 a[40:43], v4, s[48:51], s67 offen offset:2048 nt
  buffer_load_dwordx4 a[44:47], v4, s[48:51], s67 offen offset:3072 nt
  buffer_load_dwordx4 a[48:51], v105, s[48:51], s67 offen offset:0 nt
  buffer_load_dwordx4 a[52:55], v105, s[48:51], s67 offen offset:1024 nt
  buffer_load_dwordx4 a[56:59], v105, s[48:51], s67 offen offset:2048 nt
  buffer_load_dwordx4 a[60:63], v105, s[48:51], s67 offen offset:3072 nt
  s_add_u32 s77, s77, 1
  v_mov_b32 v35, s77
  ds_write_b32 v34, v35 offset:2368
  s_add_u32 s77, s77, 1
  v_mov_b32 v35, s77
  ds_write_b32 v34, v35 offset:2368
  s_branch L_ploop
L_att_done:
  v_mov_b32 v35, 0xffff
  ds_write_b32 v34, v35 offset:2368
  v_mov_b32 v64, v33
  s_nop 1
  v_permlane16_swap_b32 v33, v64
  v_add_f32 v33, v33, v64
  v_mov_b32 v64, v33
  s_nop 1
  v_permlane32_swap_b32 v33, v64
  v_add_f32 v33, v33, v64
  v_lshlrev_b32 v1, 4, v0
  v_lshlrev_b32 v6, 3, v0
  s_cmp_eq_u32 s3, 2
  s_cbranch_scc1 L_att0
  ds_write_b128 v1, v[28:31] offset:4864
  ds_write_b64 v6, v[32:33] offset:5888
  s_waitcnt lgkmcnt(0)
  s_barrier
  s_branch L_att_join
L_att0:
  s_lshl_b32 s64, s39, 10
  s_add_u32 s64, s64, 327680
  s_lshl_b32 s65, s39, 7
  s_add_u32 s65, s65, 589824
  s_barrier
  ds_read_b128 v[68:71], v1 offset:4864
  ds_read_b64 v[72:73], v6 offset:5888
  s_waitcnt lgkmcnt(0)
  v_max_f32 v74, v32, v72
  v_sub_f32 v75, v32, v74
  v_sub_f32 v76, v72, v74
  v_exp_f32 v75, v75
  v_exp_f32 v76, v76
  v_mul_f32 v28, v28, v75
  v_fmac_f32 v28, v68, v76
  v_mul_f32 v29, v29, v75
  v_fmac_f32 v29, v69, v76
  v_mul_f32 v30, v30, v75
  v_fmac_f32 v30, v70, v76
  v_mul_f32 v31, v31, v75
  v_fmac_f32 v31, v71, v76
  v_mul_f32 v33, v33, v75
  v_fmac_f32 v33, v73, v76
  buffer_store_dwordx4 v[28:31], v1, s[52:55], s64 offen sc1
  v_readlane_b32 s66, v74, 0
  v_readlane_b32 s67, v33, 0
  v_readlane_b32 s68, v74, 4
  v_readlane_b32 s69, v33, 4
  v_mov_b32 v68, s66
  v_mov_b32 v69, s67
  v_mov_b32 v70, s68
  v_mov_b32 v71, s69
  s_mov_b64 exec, 0xff
  buffer_store_dwordx4 v[68:71], v1, s[52:55], s65 offen sc1
  s_mov_b64 exec, -1
L_att_join:
  s_cmp_eq_u32 s32, 255
  s_cbranch_scc1 L_end
  v_lshrrev_b32 v24, 4, v0
  v_bfe_u32 v25, v0, 2, 2
  v_lshl_add_u32 v100, v24, 3, v25
  v_lshlrev_b32 v100, 7, v100
  v_and_b32 v24, 1, v24
  v_lshlrev_b32 v24, 1, v24
  v_lshrrev_b32 v25, 1, v25
  v_or_b32 v24, v24, v25
  v_lshlrev_b32 v24, 1, v24
  v_bfe_u32 v25, v0, 1, 1
  v_xor_b32 v24, v24, v25
  v_lshl_add_u32 v100, v24, 4, v100
  v_and_b32 v24, 1, v0
  v_lshl_add_u32 v100, v24, 3, v100
  v_xor_b32 v101, 32, v100
  v_xor_b32 v102, 64, v100
  v_xor_b32 v103, 96, v100
  s_lshl_b32 s64, s3, 5
  v_xor_b32 v100, s64, v100
  v_and_b32 v104, 1, v0
  v_mul_u32_u24 v104, 576, v104
  v_lshrrev_b32 v24, 4, v0
  v_lshl_add_u32 v104, v24, 4, v104
  v_lshlrev_b32 v105, 4, v0
  v_mov_b32 v9, s41
  v_mov_b32 v11, s41
  s_lshl_b32 s87, s32, 14
  s_lshl_b32 s65, s36, 10
  s_add_u32 s87, s87, s65
  s_lshl_b32 s65, s3, 8
  s_add_u32 s87, s87, s65
  s_add_u32 s87, s87, 1769472
  s_branch L_wogemv
L_end:
L_exit:
  s_endpgm
.p2align 6
.type L_table,@object
L_table:
  .long 0, 115, 0, 0, 0, 0, 0, 0
  .long 115, 111, 1, 0, 255, 255, 0, 0
  .long 226, 111, 2, 0, 4, 255, 0, 0
  .long 337, 111, 3, 0, 5, 255, 0, 0
  .long 448, 115, 0, 0, 1, 255, 0, 0
  .long 563, 111, 1, 1, 255, 255, 0, 0
  .long 674, 111, 2, 1, 6, 255, 0, 0
  .long 785, 111, 3, 1, 255, 255, 0, 0
  .long 0, 112, 1, 2, 8, 255, 0, 0
  .long 112, 115, 0, 0, 2, 255, 0, 0
  .long 227, 111, 2, 2, 255, 255, 0, 0
  .long 338, 111, 3, 2, 255, 255, 0, 0
  .long 449, 111, 1, 3, 255, 255, 0, 0
  .long 560, 114, 0, 0, 3, 1, 0, 0
  .long 674, 111, 2, 3, 255, 255, 0, 0
  .long 785, 111, 3, 3, 7, 255, 0, 0
  .long 0, 112, 1, 4, 255, 255, 0, 0
  .long 112, 111, 2, 4, 4, 255, 0, 0
  .long 223, 114, 0, 0, 0, 2, 0, 0
  .long 337, 111, 3, 4, 255, 255, 0, 0
  .long 448, 111, 1, 5, 5, 255, 0, 0
  .long 559, 111, 2, 5, 255, 255, 0, 0
  .long 670, 115, 0, 0, 1, 255, 0, 0
  .long 785, 111, 3, 5, 255, 255, 0, 0
  .long 0, 112, 1, 6, 7, 255, 0, 0
  .long 112, 111, 2, 6, 8, 255, 0, 0
  .long 223, 111, 3, 6, 255, 255, 0, 0
  .long 334, 115, 0, 0, 2, 255, 0, 0
  .long 449, 111, 1, 7, 255, 255, 0, 0
  .long 560, 111, 2, 7, 6, 255, 0, 0
  .long 671, 111, 3, 7, 255, 255, 0, 0
  .long 782, 114, 0, 0, 3, 3, 0, 0
  .long 0, 115, 0, 0, 0, 4, 0, 0
  .long 115, 111, 1, 8, 255, 255, 0, 0
  .long 226, 111, 2, 8, 4, 255, 0, 0
  .long 337, 111, 3, 8, 5, 255, 0, 0
  .long 448, 115, 0, 0, 1, 255, 0, 0
  .long 563, 111, 1, 9, 255, 255, 0, 0
  .long 674, 111, 2, 9, 6, 255, 0, 0
  .long 785, 111, 3, 9, 255, 255, 0, 0
  .long 0, 112, 1, 10, 255, 255, 0, 0
  .long 112, 115, 0, 0, 2, 255, 0, 0
  .long 227, 111, 2, 10, 8, 255, 0, 0
  .long 338, 111, 3, 10, 255, 255, 0, 0
  .long 449, 111, 1, 11, 255, 255, 0, 0
  .long 560, 114, 0, 0, 3, 5, 0, 0
  .long 674, 111, 2, 11, 255, 255, 0, 0
  .long 785, 111, 3, 11, 7, 255, 0, 0
  .long 0, 112, 1, 12, 255, 255, 0, 0
  .long 112, 111, 2, 12, 255, 255, 0, 0
  .long 223, 114, 0, 0, 0, 6, 0, 0
  .long 337, 111, 3, 12, 255, 255, 0, 0
  .long 448, 111, 1, 13, 4, 255, 0, 0
  .long 559, 111, 2, 13, 5, 255, 0, 0
  .long 670, 115, 0, 0, 1, 255, 0, 0
  .long 785, 111, 3, 13, 255, 255, 0, 0
  .long 0, 112, 1, 14, 6, 255, 0, 0
  .long 112, 111, 2, 14, 7, 255, 0, 0
  .long 223, 111, 3, 14, 255, 255, 0, 0
  .long 334, 115, 0, 0, 2, 255, 0, 0
  .long 449, 111, 1, 15, 8, 255, 0, 0
  .long 560, 111, 2, 15, 255, 255, 0, 0
  .long 671, 111, 3, 15, 255, 255, 0, 0
  .long 782, 114, 0, 0, 3, 7, 0, 0
  .long 0, 115, 0, 0, 0, 255, 0, 0
  .long 115, 112, 1, 16, 255, 255, 0, 0
  .long 227, 112, 2, 16, 255, 255, 0, 0
  .long 339, 112, 3, 16, 2, 255, 0, 0
  .long 451, 112, 1, 17, 255, 255, 0, 0
  .long 563, 111, 2, 17, 3, 255, 0, 0
  .long 674, 111, 3, 17, 4, 255, 0, 0
  .long 785, 111, 1, 18, 5, 255, 0, 0
  .long 0, 112, 2, 18, 255, 255, 0, 0
  .long 112, 115, 0, 0, 1, 255, 0, 0
  .long 227, 112, 3, 18, 6, 255, 0, 0
  .long 339, 112, 1, 19, 7, 255, 0, 0
  .long 451, 112, 2, 19, 8, 255, 0, 0
  .long 563, 111, 3, 19, 255, 255, 0, 0
  .long 674, 111, 1, 20, 255, 255, 0, 0
  .long 785, 111, 2, 20, 255, 255, 0, 0
  .long 0, 112, 3, 20, 255, 255, 0, 0
  .long 112, 112, 1, 21, 255, 255, 0, 0
  .long 224, 115, 0, 0, 0, 255, 0, 0
  .long 339, 112, 2, 21, 255, 255, 0, 0
  .long 451, 112, 3, 21, 255, 255, 0, 0
  .long 563, 111, 1, 22, 2, 255, 0, 0
  .long 674, 111, 2, 22, 3, 255, 0, 0
  .long 785, 111, 3, 22, 4, 255, 0, 0
  .long 0, 112, 1, 23, 5, 255, 0, 0
  .long 112, 112, 2, 23, 6, 255, 0, 0
  .long 224, 112, 3, 23, 255, 255, 0, 0
  .long 336, 115, 0, 0, 1, 255, 0, 0
  .long 451, 112, 1, 24, 7, 255, 0, 0
  .long 563, 111, 2, 24, 8, 255, 0, 0
  .long 674, 111, 3, 24, 255, 255, 0, 0
  .long 785, 111, 1, 25, 255, 255, 0, 0
  .long 0, 112, 2, 25, 4, 255, 0, 0
  .long 112, 112, 3, 25, 5, 255, 0, 0
  .long 224, 112, 1, 26, 255, 255, 0, 0
  .long 336, 112, 2, 26, 255, 255, 0, 0
  .long 448, 115, 0, 0, 0, 255, 0, 0
  .long 563, 111, 3, 26, 255, 255, 0, 0
  .long 674, 111, 1, 27, 2, 255, 0, 0
  .long 785, 111, 2, 27, 3, 255, 0, 0
  .long 0, 112, 3, 27, 255, 255, 0, 0
  .long 112, 112, 1, 28, 255, 255, 0, 0
  .long 224, 112, 2, 28, 6, 255, 0, 0
  .long 336, 112, 3, 28, 7, 255, 0, 0
  .long 448, 112, 1, 29, 255, 255, 0, 0
  .long 560, 114, 0, 0, 1, 8, 0, 0
  .long 674, 111, 2, 29, 8, 255, 0, 0
  .long 785, 111, 3, 29, 255, 255, 0, 0
  .long 0, 112, 1, 30, 2, 255, 0, 0
  .long 112, 112, 2, 30, 3, 255, 0, 0
  .long 224, 112, 3, 30, 4, 255, 0, 0
  .long 336, 112, 1, 31, 255, 255, 0, 0
  .long 448, 111, 2, 31, 255, 255, 0, 0
  .long 559, 111, 3, 31, 255, 255, 0, 0
  .long 670, 115, 0, 0, 0, 255, 0, 0
  .long 785, 111, 1, 32, 255, 255, 0, 0
  .long 0, 112, 2, 32, 8, 255, 0, 0
  .long 112, 112, 3, 32, 255, 255, 0, 0
  .long 224, 112, 1, 33, 255, 255, 0, 0
  .long 336, 112, 2, 33, 5, 255, 0, 0
  .long 448, 111, 3, 33, 6, 255, 0, 0
  .long 559, 111, 1, 34, 7, 255, 0, 0
  .long 670, 111, 2, 34, 255, 255, 0, 0
  .long 781, 115, 0, 0, 1, 255, 0, 0
  .long 0, 115, 0, 0, 0, 255, 0, 0
  .long 115, 112, 3, 34, 255, 255, 0, 0
  .long 227, 112, 1, 35, 3, 255, 0, 0
  .long 339, 112, 2, 35, 4, 255, 0, 0
  .long 451, 112, 3, 35, 5, 255, 0, 0
  .long 563, 111, 1, 36, 255, 255, 0, 0
  .long 674, 111, 2, 36, 255, 255, 0, 0
  .long 785, 111, 3, 36, 2, 255, 0, 0
  .long 0, 112, 1, 37, 255, 255, 0, 0
  .long 112, 115, 0, 0, 1, 255, 0, 0
  .long 227, 112, 2, 37, 255, 255, 0, 0
  .long 339, 112, 3, 37, 255, 255, 0, 0
  .long 451, 112, 1, 38, 255, 255, 0, 0
  .long 563, 111, 2, 38, 6, 255, 0, 0
  .long 674, 111, 3, 38, 7, 255, 0, 0
  .long 785, 111, 1, 39, 8, 255, 0, 0
  .long 0, 112, 2, 39, 255, 255, 0, 0
  .long 112, 112, 3, 39, 2, 255, 0, 0
  .long 224, 115, 0, 0, 0, 255, 0, 0
  .long 339, 112, 1, 40, 255, 255, 0, 0
  .long 451, 112, 2, 40, 3, 255, 0, 0
  .long 563, 111, 3, 40, 4, 255, 0, 0
  .long 674, 111, 1, 41, 255, 255, 0, 0
  .long 785, 111, 2, 41, 255, 255, 0, 0
  .long 0, 112, 3, 41, 7, 255, 0, 0
  .long 112, 112, 1, 42, 8, 255, 0, 0
  .long 224, 112, 2, 42, 255, 255, 0, 0
  .long 336, 115, 0, 0, 1, 255, 0, 0
  .long 451, 112, 3, 42, 255, 255, 0, 0
  .long 563, 111, 1, 43, 255, 255, 0, 0
  .long 674, 111, 2, 43, 5, 255, 0, 0
  .long 785, 111, 3, 43, 6, 255, 0, 0
  .long 0, 112, 1, 44, 255, 255, 0, 0
  .long 112, 112, 2, 44, 255, 255, 0, 0
  .long 224, 112, 3, 44, 2, 255, 0, 0
  .long 336, 112, 1, 45, 3, 255, 0, 0
  .long 448, 115, 0, 0, 0, 255, 0, 0
  .long 563, 111, 2, 45, 255, 255, 0, 0
  .long 674, 111, 3, 45, 4, 255, 0, 0
  .long 785, 111, 1, 46, 5, 255, 0, 0
  .long 0, 112, 2, 46, 6, 255, 0, 0
  .long 112, 112, 3, 46, 7, 255, 0, 0
  .long 224, 112, 1, 47, 8, 255, 0, 0
  .long 336, 112, 2, 47, 255, 255, 0, 0
  .long 448, 111, 3, 47, 255, 255, 0, 0
  .long 559, 115, 0, 0, 1, 255, 0, 0
  .long 674, 111, 1, 48, 255, 255, 0, 0
  .long 785, 111, 2, 48, 255, 255, 0, 0
  .long 0, 112, 3, 48, 255, 255, 0, 0
  .long 112, 112, 1, 49, 255, 255, 0, 0
  .long 224, 112, 2, 49, 255, 255, 0, 0
  .long 336, 112, 3, 49, 2, 255, 0, 0
  .long 448, 111, 1, 50, 3, 255, 0, 0
  .long 559, 111, 2, 50, 4, 255, 0, 0
  .long 670, 115, 0, 0, 0, 255, 0, 0
  .long 785, 111, 3, 50, 255, 255, 0, 0
  .long 0, 112, 1, 51, 5, 255, 0, 0
  .long 112, 112, 2, 51, 6, 255, 0, 0
  .long 224, 112, 3, 51, 7, 255, 0, 0
  .long 336, 112, 1, 52, 8, 255, 0, 0
  .long 448, 111, 2, 52, 255, 255, 0, 0
  .long 559, 111, 3, 52, 255, 255, 0, 0
  .long 670, 111, 1, 53, 255, 255, 0, 0
  .long 781, 115, 0, 0, 1, 255, 0, 0
  .long 0, 115, 0, 0, 0, 255, 0, 0
  .long 115, 112, 2, 53, 255, 255, 0, 0
  .long 227, 112, 3, 53, 255, 255, 0, 0
  .long 339, 112, 1, 54, 255, 255, 0, 0
  .long 451, 112, 2, 54, 2, 255, 0, 0
  .long 563, 111, 3, 54, 3, 255, 0, 0
  .long 674, 111, 1, 55, 4, 255, 0, 0
  .long 785, 111, 2, 55, 5, 255, 0, 0
  .long 0, 112, 3, 55, 255, 255, 0, 0
  .long 112, 115, 0, 0, 1, 255, 0, 0
  .long 227, 112, 1, 56, 6, 255, 0, 0
  .long 339, 112, 2, 56, 7, 255, 0, 0
  .long 451, 112, 3, 56, 8, 255, 0, 0
  .long 563, 111, 1, 57, 255, 255, 0, 0
  .long 674, 111, 2, 57, 255, 255, 0, 0
  .long 785, 111, 3, 57, 255, 255, 0, 0
  .long 0, 112, 1, 58, 255, 255, 0, 0
  .long 112, 112, 2, 58, 255, 255, 0, 0
  .long 224, 115, 0, 0, 0, 255, 0, 0
  .long 339, 112, 3, 58, 255, 255, 0, 0
  .long 451, 112, 1, 59, 255, 255, 0, 0
  .long 563, 111, 2, 59, 2, 255, 0, 0
  .long 674, 111, 3, 59, 3, 255, 0, 0
  .long 785, 111, 1, 60, 4, 255, 0, 0
  .long 0, 112, 2, 60, 5, 255, 0, 0
  .long 112, 112, 3, 60, 6, 255, 0, 0
  .long 224, 112, 1, 61, 255, 255, 0, 0
  .long 336, 115, 0, 0, 1, 255, 0, 0
  .long 451, 112, 2, 61, 7, 255, 0, 0
  .long 563, 111, 3, 61, 8, 255, 0, 0
  .long 674, 111, 1, 62, 255, 255, 0, 0
  .long 785, 111, 2, 62, 255, 255, 0, 0
  .long 0, 112, 3, 62, 4, 255, 0, 0
  .long 112, 112, 1, 63, 5, 255, 0, 0
  .long 224, 112, 2, 63, 255, 255, 0, 0
  .long 336, 112, 3, 63, 255, 255, 0, 0
  .long 448, 115, 0, 0, 0, 255, 0, 0
  .long 563, 111, 1, 64, 255, 255, 0, 0
  .long 674, 111, 2, 64, 2, 255, 0, 0
  .long 785, 111, 3, 64, 3, 255, 0, 0
  .long 0, 112, 1, 65, 255, 255, 0, 0
  .long 112, 112, 2, 65, 255, 255, 0, 0
  .long 224, 112, 3, 65, 6, 255, 0, 0
  .long 336, 112, 1, 66, 7, 255, 0, 0
  .long 448, 111, 2, 66, 255, 255, 0, 0
  .long 559, 115, 0, 0, 1, 255, 0, 0
  .long 674, 111, 3, 66, 8, 255, 0, 0
  .long 785, 111, 1, 67, 255, 255, 0, 0
  .long 0, 112, 2, 67, 2, 255, 0, 0
  .long 112, 112, 3, 67, 3, 255, 0, 0
  .long 224, 112, 1, 68, 4, 255, 0, 0
  .long 336, 112, 2, 68, 255, 255, 0, 0
  .long 448, 111, 3, 68, 255, 255, 0, 0
  .long 559, 111, 1, 69, 255, 255, 0, 0
  .long 670, 115, 0, 0, 0, 255, 0, 0
  .long 785, 111, 2, 69, 255, 255, 0, 0
  .long 0, 112, 3, 69, 8, 255, 0, 0
  .long 112, 112, 1, 70, 255, 255, 0, 0
  .long 224, 112, 2, 70, 255, 255, 0, 0
  .long 336, 112, 3, 70, 5, 255, 0, 0
  .long 448, 111, 1, 71, 6, 255, 0, 0
  .long 559, 111, 2, 71, 7, 255, 0, 0
  .long 670, 111, 3, 71, 255, 255, 0, 0
  .long 781, 115, 0, 0, 1, 255, 0, 0
.size L_table, 8192
.section .rodata,"a"
.p2align 6
.amdhsa_kernel recurrent_scan__gqa_block_cached__geglu_ffn__decode_kernel
  .amdhsa_next_free_vgpr 512
  .amdhsa_next_free_sgpr 102
  .amdhsa_accum_offset 256
  .amdhsa_group_segment_fixed_size 0
  .amdhsa_kernarg_size 96
  .amdhsa_user_sgpr_count 2
  .amdhsa_user_sgpr_kernarg_segment_ptr 1
  .amdhsa_system_sgpr_workgroup_id_x 1
  .amdhsa_float_denorm_mode_32 3
.end_amdhsa_kernel
```
